```python
import torch

def _softmax(x, axis=-1):
    return torch.softmax(x, dim=axis)
def _gelu(x):
    return torch.nn.functional.gelu(x, approximate="tanh")
def _silu(x):
    return torch.nn.functional.silu(x)
def _sigmoid(x):
    return torch.sigmoid(x)
def _layernorm(x, axis=-1, eps=1e-5):
    m = x.mean(dim=axis, keepdim=True)
    v = x.var(dim=axis, keepdim=True, unbiased=False)
    return (x - m) / torch.sqrt(v + eps)
def _scatter_add(tgt, idx, src, axis=0):
    return tgt.clone().index_add_(axis, idx, src)
def _segment_sum(src, seg, n):
    out = torch.zeros((n,) + src.shape[1:], dtype=src.dtype)
    return out.index_add_(0, seg, src)
def _pad(x, pw):
    flat = tuple(v for pair in reversed(pw) for v in pair)
    return torch.nn.functional.pad(x, flat)

kernel_name = 'standalone__attention_interact_autoint__recsys'

def setup_inputs():

    _w = (lambda a: (lambda t: t.to(torch.bfloat16) if t.is_floating_point() else t)(torch.as_tensor(a)))
    B, F = 1024, 100
    D = max(2, (64 // 2) * 2)
    H = 2
    Dh = D // H
    return {
        "e": _w((lambda *s: torch.randn(*s, dtype=torch.bfloat16) * 0.05)(B, F, D).to(float)),
        "wq": _w((lambda *s: torch.randn(*s, dtype=torch.bfloat16) * 3.2)(H, D, Dh).to(float)),
        "wk": _w((lambda *s: torch.randn(*s, dtype=torch.bfloat16) * 3.2)(H, D, Dh).to(float)),
        "wv": _w((lambda *s: torch.randn(*s, dtype=torch.bfloat16) * 0.05)(H, D, Dh).to(float)),
        "wres": _w((lambda *s: torch.randn(*s, dtype=torch.bfloat16) * 0.05)(D, D).to(float)),
    }

def reference(e, wq, wk, wv, wres):
    H, D, Dh = wq.shape[0], wq.shape[1], wq.shape[2]
    B, F = e.shape[0], e.shape[1]
    q = torch.einsum('bfd,hdk->bhfk', e, wq)
    k = torch.einsum('bfd,hdk->bhfk', e, wk)
    v = torch.einsum('bfd,hdk->bhfk', e, wv)
    scale = float(Dh) ** -0.5
    scores = torch.einsum('bhfk,bhgk->bhfg', q, k) * scale
    attn = _softmax(scores, axis=-1)
    attn = (lambda x, dt: x.to(dt))(attn, v.dtype)
    ctx = torch.einsum('bhfg,bhgk->bhfk', attn, v)
    ctx = (lambda x, *d: x.permute(*d))(ctx, 0, 2, 1, 3).reshape(B, F, H * Dh)
    res = torch.einsum('bfd,de->bfe', e, wres)
    out = ctx + res
    mask = (lambda x, dt: x.to(dt))(out > 0, out.dtype)
    return out * mask
```

```asm
; @launch grid=(256,1,1) block=(512,1,1) lds=131840
.amdgcn_target "amdgcn-amd-amdhsa--gfx950"
.text
.globl standalone__attention_interact_autoint__recsys_kernel
.p2align 8
.type standalone__attention_interact_autoint__recsys_kernel,@function
standalone__attention_interact_autoint__recsys_kernel:
    s_load_dwordx8 s[4:11], s[0:1], 0
    s_load_dwordx4 s[12:15], s[0:1], 32
    s_getpc_b64 s[28:29]
L_pc:
    v_lshlrev_b32 v241, 7, v0
    s_mov_b32 s30, L_safe-L_pc
    s_mov_b32 s31, 0x20000
    s_cmp_ge_u32 s2, 256
    s_cbranch_scc1 L_end
    v_readfirstlane_b32 s37, v0
    buffer_load_dword v251, v241, s[28:31], 0 offen
    v_bfe_u32 v242, v0, 4, 2
    v_xor_b32 v242, v242, v0
    v_and_b32 v242, 7, v242
    v_lshlrev_b32_e64 v242, 4, v242
    v_and_b32_e64 v247, 0x38, v0
    v_lshl_add_u32 v247, v247, 4, v242
    s_mul_i32 s51, s2, 51200
    s_lshr_b32 s33, s37, 7
    s_mul_i32 s38, s33, 12800
    s_add_u32 s38, s38, s51
    s_mul_i32 s35, s33, 12288
    s_add_u32 s35, s35, 32768
    s_bfe_u32 s41, s37, 0x20006
    s_lshl_b32 s43, s41, 11
    v_and_b32 v241, 63, v0
    v_lshl_add_u32 v248, v241, 4, s43
    s_and_b32 s46, s37, 64
    s_lshl_b32 s46, s46, 5
    s_add_u32 s47, s46, s38
    v_add_u32 v245, s47, v247
    s_add_u32 s42, s35, s46
    v_xor_b32 v246, 64, v245
    s_cmp_lt_u32 s37, 256
    s_cbranch_scc1 L_lo0
    s_mov_b32 m0, s43
    s_waitcnt lgkmcnt(0)
    global_load_lds_dwordx4 v248, s[6:7]
    global_load_lds_dwordx4 v248, s[6:7] offset:1024
    s_add_u32 m0, s43, 16384
    s_nop 0
    global_load_lds_dwordx4 v248, s[10:11]
    global_load_lds_dwordx4 v248, s[10:11] offset:1024
    s_branch L_join
L_lo0:
    s_mov_b32 m0, s42
    s_mul_i32 s46, s41, 12800
    s_add_u32 s46, s46, s51
    s_add_u32 s46, s46, 12288
    s_lshl_b32 s44, s41, 5
    v_bfe_u32 v242, v0, 4, 1
    v_lshl_add_u32 v242, v242, 4, s44
    v_lshlrev_b32 v252, 4, v241
    v_xad_u32 v252, v252, v242, s46
    s_lshl_b32 s44, s41, 9
    s_add_u32 s44, s44, 94208
    s_waitcnt lgkmcnt(0)
    global_load_lds_dwordx4 v245, s[4:5] nt
    global_load_lds_dwordx4 v246, s[4:5] offset:1024 nt
    s_mov_b32 m0, s44
    s_mov_b32 exec_hi, 0
    global_load_lds_dwordx4 v252, s[4:5] nt
    s_add_u32 m0, s43, 8192
    s_mov_b32 exec_hi, -1
    global_load_lds_dwordx4 v248, s[8:9]
    global_load_lds_dwordx4 v248, s[8:9] offset:1024
L_join:
    s_lshr_b32 s32, s37, 6
    s_and_b32 s34, s32, 1
    s_add_u32 s24, s14, s38
    s_addc_u32 s25, s15, 0
    s_mov_b32 s26, 12800
    s_mov_b32 s27, 0x20000
    s_mov_b32 s39, 4096
    s_mov_b32 s40, 8192
    s_mov_b32 s45, 0x3e8293ee
    s_mul_i32 s36, s32, 3328
    s_add_u32 s36, s36, 97024
    s_add_u32 s49, s36, 2048
    s_lshl_b32 s46, s34, 10
    s_lshl_b32 s47, s33, 8
    s_add_u32 s52, s46, s47
    s_lshl_b32 s52, s52, 1
    s_lshl_b32 s47, s33, 6
    s_add_u32 s48, s46, s47
    s_add_u32 s48, s48, 81920
    s_add_u32 s52, s52, 86016
    s_lshl_b32 s50, s34, 6
    s_lshl_b32 s46, s34, 12
    s_cmp_lt_u32 s32, 4
    s_cbranch_scc1 L_j2
    s_mov_b32 m0, s42
    s_nop 0
    global_load_lds_dwordx4 v245, s[4:5] nt
    global_load_lds_dwordx4 v246, s[4:5] offset:1024 nt
L_j2:
    v_bfe_u32 v27, v0, 5, 1
    v_bfe_u32 v241, v0, 2, 2
    v_lshl_add_u32 v243, v27, 3, v241
    v_lshl_add_u32 v243, v243, 6, s46
    v_and_b32_e64 v242, 16, v0
    v_lshl_add_u32 v243, v242, 1, v243
    v_and_b32 v242, 3, v0
    v_lshlrev_b32 v242, 3, v242
    v_add_u32 v26, v242, v243
    v_and_b32 v244, 1, v0
    v_lshlrev_b32 v244, 4, v244
    v_and_b32 v240, 2, v0
    v_lshl_add_u32 v244, v240, 2, v244
    v_add_u32_e64 v8, v244, v243
    v_cmp_gt_u32 vcc, 256, v0
    s_nop 1
    v_cndmask_b32 v242, v244, v242, vcc
    v_lshl_add_u32 v253, v241, 6, v242
    v_and_b32_e64 v241, 48, v0
    v_lshl_add_u32 v253, v241, 5, v253
    s_lshl_b32 s46, s32, 12
    s_lshl_b32 s47, s34, 12
    s_add_u32 s47, s47, 16384
    s_lshl_b32 s53, s33, 5
    s_and_b32 s53, s53, 32
    s_add_u32 s47, s47, s53
    s_cmp_lt_u32 s32, 4
    s_cselect_b32 s46, s46, s47
    v_add_u32 v253, s46, v253
    v_add_u32 v28, 123648, v26
    s_cmp_lt_u32 s32, 2
    s_cselect_b32 s53, s45, 1.0
    v_bfe_u32 v242, v0, 1, 3
    v_bfe_u32 v243, v0, 4, 2
    s_mov_b32 s44, 94208
    v_xor_b32_e64 v242, v242, v243
    v_lshl_add_u32 v242, v242, 4, s44
    v_and_b32_e64 v243, 15, v0
    v_lshl_add_u32 v254, v243, 7, v242
    v_xor_b32 v252, 64, v254
    v_mov_b32 v24, 0
    v_mov_b32 v25, 0
    v_mov_b32 v19, 0
    v_and_b32_e64 v241, 63, v0
    v_lshl_add_u32 v241, v241, 3, s44
    ds_write_b64 v241, v[24:25] offset:2176
    v_bfe_u32 v241, v0, 1, 3
    v_xor_b32_e64 v241, v241, v27
    v_lshl_add_u32 v241, v241, 4, s35
    v_and_b32_e64 v240, 31, v0
    v_lshl_add_u32 v1, v240, 7, v241
    v_xor_b32 v2, 32, v1
    v_xor_b32 v3, 64, v1
    v_xor_b32 v4, 96, v1
    s_cmp_ge_u32 s37, 256
    s_cbranch_scc1 L_hi1
    v_bfe_u32 v240, v0, 3, 1
    v_and_b32 v241, 1, v0
    v_lshl_add_u32 v241, v240, 1, v241
    v_lshl_add_u32 v240, v27, 9, s48
    v_lshl_add_u32 v6, v241, 4, v240
    v_add_u32 v5, 2048, v6
    v_add_u32_e64 v240, v27, v241
    v_lshl_add_u32 v240, v240, 4, s49
    v_lshl_add_u32 v16, v241, 8, v240
    v_lshrrev_b32 v241, 2, v0
    v_xor_b32 v241, v241, v0
    v_and_b32 v242, 4, v241
    v_cmp_eq_u32 vcc, 0, v242
    v_mov_b32 v240, 0x3f803f80
    s_nop 0
    v_cndmask_b32 v20, 0, v240, vcc
    v_and_or_b32 v241, v0, 2, v242
    v_cmp_eq_u32 vcc, 0, v241
    v_mov_b32 v241, 96384
    s_nop 0
    v_cndmask_b32 v6, v241, v6, vcc
    v_cndmask_b32 v5, v241, v5, vcc
    v_cndmask_b32 v16, v241, v16, vcc
    v_mov_b32 v21, v20
    v_mov_b32 v22, v20
    v_mov_b32 v23, v20
    v_and_b32_e64 v243, 31, v0
    v_lshl_add_u32 v240, v243, 4, s52
    v_lshl_add_u32 v7, v27, 3, v240
    v_mov_b32 v17, 0
    v_and_b32 v240, 0x13, v0
    v_and_b32_e64 v241, 4, v0
    v_lshl_add_u32 v240, v241, 1, v240
    v_bfe_u32 v241, v0, 3, 1
    v_lshl_add_u32 v240, v241, 2, v240
    v_lshlrev_b32_e64 v240, 1, v240
    v_lshl_add_u32 v242, v27, 8, v240
    v_add_u32_e64 v242, s50, v242
    v_add_u32 v13, 12288, v242
    v_lshl_add_u32 v242, v27, 9, s49
    v_lshl_add_u32 v242, v27, 5, v242
    v_add_u32 v14, v242, v240
    v_and_b32 v240, 3, v0
    v_lshl_add_u32 v240, v241, 3, v240
    v_lshlrev_b32_e64 v240, 1, v240
    v_add_u32 v240, 192, v240
    v_and_b32 v241, 0x14, v0
    v_cmp_eq_u32 vcc, 0, v241
    v_mov_b32 v241, 240
    s_nop 0
    v_cndmask_b32 v240, v241, v240, vcc
    v_add_u32 v15, v242, v240
    v_bfe_u32 v240, v0, 1, 2
    v_xor_b32 v240, v240, v27
    v_lshl_add_u32 v240, v240, 4, s36
    v_and_b32_e64 v243, 31, v0
    v_lshl_add_u32 v9, v243, 6, v240
    v_xor_b32 v10, 32, v9
    v_lshrrev_b32 v240, 3, v0
    v_xor_b32_e64 v240, v240, v0
    v_and_b32_e64 v240, 3, v240
    v_lshl_add_u32 v240, v240, 4, s36
    v_bfe_u32 v241, v0, 2, 4
    v_lshl_add_u32 v11, v241, 6, v240
    v_and_b32_e64 v240, 3, v0
    v_lshl_add_u32 v240, v240, 4, s50
    v_lshl_add_u32 v12, v241, 7, v240
    s_lshl_b32 s46, s32, 10
    s_add_u32 s46, s46, 81920
    v_and_b32 v241, 15, v0
    v_and_b32_e64 v242, 16, v0
    v_lshl_add_u32 v241, v241, 4, s46
    v_lshl_add_u32 v242, v242, 5, v241
    v_lshl_add_u32 v255, v27, 3, v242
    s_add_u32 m0, s42, 4096
    v_add_u32 v245, 4096, v245
    v_add_u32 v246, 4096, v246
    global_load_lds_dwordx4 v245, s[4:5] nt
    global_load_lds_dwordx4 v246, s[4:5] offset:1024 nt
    v_and_b32 v242, 0x7c, v0
    v_and_b32_e64 v243, 64, v0
    v_add_u32_e64 v242, v242, v243
    v_and_b32 v243, 48, v248
    v_lshl_add_u32 v249, v242, 5, v243
    v_bfe_u32 v242, v0, 7, 1
    v_lshl_add_u32 v249, v242, 6, v249
    s_add_u32 m0, s43, 24576
    v_add_u32 v250, 1024, v249
    global_load_lds_dwordx4 v249, s[12:13]
    global_load_lds_dwordx4 v250, s[12:13] offset:1024
    s_waitcnt lgkmcnt(0)
L_lo:
    s_waitcnt vmcnt(4)
    s_barrier
    ds_read_b128 v[96:99], v254
    ds_read_b64_tr_b16 v[78:79], v253 offset:256
    ds_read_b128 v[216:219], v2
    ds_read_b128 v[220:223], v1
    ds_read_b64_tr_b16 v[192:193], v26 offset:0
    ds_read_b64_tr_b16 v[194:195], v26 offset:256
    ds_read_b64_tr_b16 v[68:69], v26 offset:1024
    ds_read_b64_tr_b16 v[172:173], v253 offset:2080
    ds_read_b128 v[212:215], v252
    ds_read_b64_tr_b16 v[76:77], v253 offset:0
    ds_read_b64_tr_b16 v[40:41], v26 offset:10240
    ds_read_b64_tr_b16 v[210:211], v253 offset:288
    ds_read_b64_tr_b16 v[242:243], v26 offset:2304
    ds_read_b128 v[72:75], v3
    ds_read_b64_tr_b16 v[208:209], v253 offset:32
    ds_read_b64_tr_b16 v[204:205], v253 offset:2048
    ds_read_b64_tr_b16 v[200:201], v26 offset:3072
    ds_read_b64_tr_b16 v[36:37], v26 offset:9216
    ds_read_b64_tr_b16 v[240:241], v26 offset:2048
    s_waitcnt lgkmcnt(13)
    v_mfma_f32_32x32x16_bf16 v[144:159], v[192:195], v[220:223], 0
    ds_read_b64_tr_b16 v[206:207], v253 offset:2304
    ds_read_b128 v[196:199], v4
    ds_read_b64_tr_b16 v[86:87], v8 offset:17664
    ds_read_b64_tr_b16 v[90:91], v8 offset:18688
    ds_read_b64_tr_b16 v[32:33], v26 offset:8192
    ds_read_b64_tr_b16 v[70:71], v26 offset:1280
    ds_read_b64_tr_b16 v[174:175], v253 offset:2336
    ds_read_b64_tr_b16 v[202:203], v26 offset:3328
    s_waitcnt lgkmcnt(15)
    v_mfma_f32_16x16x32_bf16 v[136:139], v[76:79], v[96:99], 0
    ds_read_b64_tr_b16 v[46:47], v26 offset:11520
    ds_read_b64_tr_b16 v[38:39], v26 offset:9472
    s_waitcnt lgkmcnt(9)
    v_mfma_f32_16x16x32_bf16 v[136:139], v[204:207], v[212:215], v[136:139]
    ds_read_b64_tr_b16 v[92:93], v8 offset:19456
    v_mfma_f32_16x16x32_bf16 v[64:67], v[208:211], v[96:99], 0
    s_waitcnt lgkmcnt(5)
    v_mfma_f32_32x32x16_bf16 v[144:159], v[68:71], v[216:219], v[144:159]
    s_waitcnt lgkmcnt(4)
    v_mfma_f32_16x16x32_bf16 v[64:67], v[172:175], v[212:215], v[64:67]
    ds_read_b64_tr_b16 v[34:35], v26 offset:8448
    v_mul_f32 v136, s53, v136
    v_mfma_f32_32x32x16_bf16 v[144:159], v[240:243], v[72:75], v[144:159]
    ds_read_b64_tr_b16 v[82:83], v8 offset:16640
    ds_read_b64_tr_b16 v[88:89], v8 offset:18432
    v_mul_f32 v137, s53, v137
    v_mul_f32 v138, s53, v138
    ds_read_b64_tr_b16 v[44:45], v26 offset:11264
    ds_read_b64_tr_b16 v[42:43], v26 offset:10496
    ds_read_b64_tr_b16 v[80:81], v8 offset:16384
    v_cvt_pk_bf16_f32 v136, v136, v137
    v_mul_f32 v67, s53, v67
    v_mul_f32 v65, s53, v65
    v_mul_f32 v139, s53, v139
    s_waitcnt lgkmcnt(9)
    v_mfma_f32_32x32x16_bf16 v[144:159], v[200:203], v[196:199], v[144:159]
    ds_read_b64_tr_b16 v[84:85], v8 offset:17408
    v_cvt_pk_bf16_f32 v137, v138, v139
    s_waitcnt lgkmcnt(6)
    v_mfma_f32_32x32x16_bf16 v[48:63], v[32:35], v[220:223], 0
    v_mul_f32 v66, s53, v66
    ds_write_b64 v255, v[136:137] offset:0
    v_mul_f32 v64, s53, v64
    v_mul_f32 v158, s45, v158
    v_mfma_f32_32x32x16_bf16 v[48:63], v[36:39], v[216:219], v[48:63]
    v_mul_f32 v144, s45, v144
    v_mul_f32 v156, s45, v156
    ds_read_b64_tr_b16 v[94:95], v8 offset:19712
    v_cvt_pk_bf16_f32 v64, v64, v65
    v_cvt_pk_bf16_f32 v65, v66, v67
    v_mul_f32 v153, s45, v153
    v_mul_f32 v146, s45, v146
    v_mul_f32 v147, s45, v147
    s_waitcnt lgkmcnt(4)
    v_mfma_f32_32x32x16_bf16 v[48:63], v[40:43], v[72:75], v[48:63]
    ds_write_b64 v255, v[64:65] offset:256
    v_mfma_f32_32x32x16_bf16 v[48:63], v[44:47], v[196:199], v[48:63]
    v_mul_f32 v149, s45, v149
    v_mul_f32 v154, s45, v154
    v_mul_f32_e64 v152, s45, v152
    v_mul_f32 v145, s45, v145
    s_waitcnt lgkmcnt(4)
    v_mfma_f32_32x32x16_bf16 v[176:191], v[220:223], v[80:83], 0
    v_cvt_pk_bf16_f32 v161, v146, v147
    v_mul_f32 v155, s45, v155
    v_mul_f32 v150, s45, v150
    v_mul_f32_e64 v157, s45, v157
    v_cvt_pk_bf16_f32 v104, v48, v49
    v_mul_f32 v148, s45, v148
    s_waitcnt lgkmcnt(3)
    v_mfma_f32_32x32x16_bf16 v[176:191], v[216:219], v[84:87], v[176:191]
    v_cvt_pk_bf16_f32 v164, v152, v153
    v_cvt_pk_bf16_f32 v107, v54, v55
    v_mfma_f32_32x32x16_bf16 v[176:191], v[72:75], v[88:91], v[176:191]
    v_cvt_pk_bf16_f32 v166, v156, v157
    v_cvt_pk_bf16_f32 v106, v52, v53
    v_mul_f32 v151, s45, v151
    v_cvt_pk_bf16_f32 v109, v58, v59
    v_cvt_pk_bf16_f32 v163, v150, v151
    v_cvt_pk_bf16_f32 v160, v144, v145
    v_cvt_pk_bf16_f32 v162, v148, v149
    s_waitcnt lgkmcnt(1)
    v_mfma_f32_32x32x16_bf16 v[176:191], v[196:199], v[92:95], v[176:191]
    s_waitcnt lgkmcnt(0)
    s_barrier
    v_cvt_pk_bf16_f32 v105, v50, v51
    v_cvt_pk_bf16_f32 v111, v62, v63
    v_cvt_pk_bf16_f32 v110, v60, v61
    v_cvt_pk_bf16_f32 v165, v154, v155
    v_mfma_f32_32x32x16_bf16 v[112:127], v[104:107], v[160:163], 0
    v_mul_f32_e64 v159, s45, v159
    v_cvt_pk_bf16_f32 v108, v56, v57
    v_cvt_pk_bf16_f32 v167, v158, v159
    s_nop 0
    s_nop 0
    v_mfma_f32_32x32x16_bf16 v[112:127], v[108:111], v[164:167], v[112:127]
    v_add_u32 v246, 4096, v246
    s_nop 9
    v_exp_f32 v116, v116
    v_exp_f32_e64 v117, v117
    v_cvt_pk_bf16_f32 v175, v190, v191
    ds_read_b128 v[228:231], v5 offset:256
    ds_read_b128 v[232:235], v6 offset:0
    v_exp_f32_e64 v114, v114
    ds_read_b64_tr_b16 v[134:135], v28 offset:1280
    ds_read_b64_tr_b16 v[132:133], v28 offset:1024
    v_exp_f32_e64 v113, v113
    s_add_u32 m0, s42, 8192
    v_cvt_pk_bf16_f32 v173, v186, v187
    v_exp_f32 v115, v115
    ds_read_b64_tr_b16 v[136:137], v28 offset:2048
    v_exp_f32 v120, v120
    v_exp_f32 v124, v124
    ds_read_b64 v[240:241], v7
    v_exp_f32 v126, v126
    v_exp_f32 v121, v121
    v_exp_f32 v112, v112
    v_cvt_pk_bf16_f32 v120, v120, v121
    v_add_u32 v245, 4096, v245
    v_cvt_pk_bf16_f32 v112, v112, v113
    v_exp_f32_e64 v118, v118
    ds_read_b64_tr_b16 v[128:129], v28 offset:0
    v_cvt_pk_bf16_f32 v171, v182, v183
    v_cvt_pk_bf16_f32 v113, v114, v115
    v_exp_f32 v122, v122
    v_exp_f32 v119, v119
    v_cvt_pk_bf16_f32 v169, v178, v179
    v_exp_f32_e64 v125, v125
    v_exp_f32_e64 v127, v127
    ds_read_b64_tr_b16 v[130:131], v28 offset:256
    v_cvt_pk_bf16_f32 v168, v176, v177
    ds_read_b128 v[236:239], v6 offset:256
    global_load_lds_dwordx4 v245, s[4:5] nt
    global_load_lds_dwordx4 v246, s[4:5] offset:1024 nt
    v_cvt_pk_bf16_f32 v114, v116, v117
    ds_read_b64_tr_b16 v[142:143], v28 offset:3328
    ds_read_b128 v[224:227], v5 offset:0
    s_waitcnt lgkmcnt(9)
    v_mfma_f32_16x16x32_bf16 v[100:103], v[232:235], v[104:107], 0
    s_setprio 2
    v_exp_f32 v123, v123
    s_waitcnt lgkmcnt(2)
    v_mfma_f32_16x16x32_bf16 v[100:103], v[236:239], v[108:111], v[100:103]
    v_cvt_pk_bf16_f32 v121, v122, v123
    v_mov_b32 v30, 0x3f803f80
    s_waitcnt vmcnt(2)
    s_barrier
    ds_read_b128 v[76:79], v1 offset:4096
    v_cvt_pk_bf16_f32 v123, v126, v127
    s_waitcnt lgkmcnt(1)
    v_mfma_f32_16x16x32_bf16 v[252:255], v[232:235], v[224:227], 0
    ds_read_b128 v[152:155], v3 offset:4096
    v_mfma_f32_16x16x32_bf16 v[156:159], v[224:227], v[160:163], 0
    ds_read_b128 v[148:151], v2 offset:4096
    v_cvt_pk_bf16_f32 v115, v118, v119
    v_mfma_f32_16x16x32_bf16 v[156:159], v[228:231], v[164:167], v[156:159]
    v_exp_f32 v100, v100
    v_mfma_f32_16x16x32_bf16 v[96:99], v[20:23], v[112:115], 0
    ds_read_b64_tr_b16 v[140:141], v28 offset:3072
    v_mfma_f32_16x16x32_bf16 v[252:255], v[236:239], v[228:231], v[252:255]
    s_waitcnt lgkmcnt(3)
    v_mfma_f32_32x32x16_bf16 v[48:63], v[128:131], v[76:79], 0
    ds_read_b64_tr_b16 v[138:139], v28 offset:2304
    ds_read_b128 v[144:147], v4 offset:4096
    v_mfma_f32_32x32x16_bf16 v[192:207], v[76:79], v[80:83], 0
    s_waitcnt lgkmcnt(3)
    v_mfma_f32_32x32x16_bf16 v[192:207], v[148:151], v[84:87], v[192:207]
    v_mfma_f32_32x32x16_bf16 v[208:223], v[32:35], v[76:79], 0
    v_mfma_f32_32x32x16_bf16 v[208:223], v[36:39], v[148:151], v[208:223]
    v_exp_f32 v156, v156
    v_mfma_f32_32x32x16_bf16 v[192:207], v[152:155], v[88:91], v[192:207]
    v_mfma_f32_32x32x16_bf16 v[208:223], v[40:43], v[152:155], v[208:223]
    v_cvt_pk_bf16_f32 v172, v184, v185
    v_cvt_pk_bf16_f32 v24, v240, v241
    s_waitcnt lgkmcnt(0)
    v_mfma_f32_32x32x16_bf16 v[208:223], v[44:47], v[144:147], v[208:223]
    v_mfma_f32_32x32x16_bf16 v[192:207], v[144:147], v[92:95], v[192:207]
    v_cvt_pk_bf16_f32 v174, v188, v189
    v_exp_f32 v157, v157
    v_cvt_pk_bf16_f32 v170, v180, v181
    v_mfma_f32_32x32x16_bf16 v[48:63], v[132:135], v[148:151], v[48:63]
    v_cvt_pk_bf16_f32 v122, v124, v125
    v_cvt_pk_bf16_f32 v18, v156, v157
    v_cvt_pk_bf16_f32 v69, v218, v219
    v_mfma_f32_32x32x16_bf16 v[48:63], v[136:139], v[152:155], v[48:63]
    s_setprio 3
    v_cvt_pk_bf16_f32 v67, v214, v215
    v_cvt_pk_bf16_f32 v244, v200, v201
    v_cvt_pk_bf16_f32 v64, v208, v209
    v_mfma_f32_32x32x16_bf16 v[48:63], v[140:143], v[144:147], v[48:63]
    v_cvt_pk_bf16_f32 v66, v212, v213
    v_cvt_pk_bf16_f32 v65, v210, v211
    v_cvt_pk_bf16_f32 v241, v194, v195
    v_cvt_pk_bf16_f32 v71, v222, v223
    v_cvt_pk_bf16_f32 v68, v216, v217
    v_mfma_f32_32x32x16_bf16 v[176:191], v[64:67], v[160:163], 0
    v_cvt_pk_bf16_f32 v243, v198, v199
    v_exp_f32_e64 v252, v252
    v_cvt_pk_bf16_f32 v70, v220, v221
    v_mfma_f32_16x16x32_bf16 v[248:251], v[232:235], v[64:67], 0
    v_cvt_pk_bf16_f32 v73, v50, v51
    v_mfma_f32_32x32x16_bf16 v[176:191], v[68:71], v[164:167], v[176:191]
    v_cvt_pk_bf16_f32 v76, v56, v57
    v_cvt_pk_bf16_f32 v240, v192, v193
    v_cvt_pk_bf16_f32 v75, v54, v55
    v_cvt_pk_bf16_f32 v247, v206, v207
    v_cvt_pk_bf16_f32 v72, v48, v49
    v_mfma_f32_16x16x32_bf16 v[96:99], v[20:23], v[120:123], v[96:99]
    v_cvt_pk_bf16_f32 v245, v202, v203
    v_mfma_f32_32x32x16_bf16 v[208:223], v[168:171], v[112:115], 0
    v_cvt_pk_bf16_f32 v242, v196, v197
    v_exp_f32_e64 v178, v178
    v_cvt_pk_bf16_f32 v74, v52, v53
    v_mfma_f32_16x16x32_bf16 v[248:251], v[236:239], v[68:71], v[248:251]
    v_exp_f32 v176, v176
    v_mfma_f32_32x32x16_bf16 v[208:223], v[172:175], v[120:123], v[208:223]
    v_exp_f32 v253, v253
    v_exp_f32 v184, v184
    v_exp_f32 v186, v186
    v_mfma_f32_32x32x16_bf16 v[112:127], v[104:107], v[72:75], 0
    v_exp_f32_e64 v101, v101
    v_cvt_pk_bf16_f32 v79, v62, v63
    v_cvt_pk_bf16_f32 v246, v204, v205
    v_cvt_pk_bf16_f32 v77, v58, v59
    v_mfma_f32_32x32x16_bf16 v[192:207], v[64:67], v[72:75], 0
    v_cvt_pk_bf16_f32 v78, v60, v61
    v_exp_f32 v177, v177
    v_exp_f32 v185, v185
    v_mfma_f32_32x32x16_bf16 v[112:127], v[108:111], v[76:79], v[112:127]
    v_exp_f32 v190, v190
    v_exp_f32 v191, v191
    v_mfma_f32_16x16x16_bf16 v[96:99], v[20:21], v[18:19], v[96:99]
    v_exp_f32 v187, v187
    v_mfma_f32_32x32x16_bf16 v[192:207], v[68:71], v[76:79], v[192:207]
    v_exp_f32 v127, v127
    v_cvt_pk_bf16_f32 v176, v176, v177
    v_exp_f32_e64 v189, v189
    v_mfma_f32_16x16x32_bf16 v[156:159], v[224:227], v[72:75], 0
    s_setprio 1
    v_exp_f32 v124, v124
    v_mfma_f32_16x16x32_bf16 v[156:159], v[228:231], v[76:79], v[156:159]
    v_exp_f32_e64 v114, v114
    v_mfma_f32_32x32x8_bf16 v[208:223], v[24:25], v[18:19], v[208:223]
    s_barrier
    v_exp_f32 v200, v200
    v_exp_f32 v122, v122
    v_exp_f32 v188, v188
    v_exp_f32 v203, v203
    v_exp_f32 v204, v204
    v_exp_f32 v197, v197
    v_exp_f32 v201, v201
    v_exp_f32 v115, v115
    v_exp_f32 v156, v156
    v_exp_f32 v118, v118
    v_exp_f32 v248, v248
    v_exp_f32 v123, v123
    v_exp_f32 v117, v117
    v_exp_f32 v181, v181
    v_exp_f32 v121, v121
    v_exp_f32 v112, v112
    v_exp_f32 v116, v116
    v_exp_f32 v182, v182
    v_exp_f32 v198, v198
    v_exp_f32 v249, v249
    v_exp_f32 v199, v199
    v_exp_f32 v119, v119
    v_exp_f32 v183, v183
    v_exp_f32 v120, v120
    v_exp_f32 v125, v125
    v_exp_f32 v180, v180
    v_exp_f32 v202, v202
    v_exp_f32 v194, v194
    v_exp_f32 v179, v179
    v_exp_f32 v157, v157
    v_exp_f32 v113, v113
    v_exp_f32_e64 v193, v193
    v_cvt_pk_bf16_f32 v120, v120, v121
    v_cvt_pk_bf16_f32 v248, v248, v249
    v_cvt_pk_bf16_f32 v184, v184, v185
    v_cvt_pk_bf16_f32 v185, v186, v187
    v_exp_f32_e64 v205, v205
    v_cvt_pk_bf16_f32 v177, v178, v179
    v_cvt_pk_bf16_f32 v100, v100, v101
    v_exp_f32_e64 v192, v192
    ds_write_b16 v14, v248 offset:64
    ds_write_b16_d16_hi v14, v100 offset:272
    ds_write_b16 v14, v100 offset:0
    v_cvt_pk_bf16_f32 v187, v190, v191
    v_cvt_pk_bf16_f32 v18, v156, v157
    v_exp_f32_e64 v195, v195
    v_cvt_pk_bf16_f32 v112, v112, v113
    v_exp_f32 v126, v126
    s_waitcnt vmcnt(0)
    v_cvt_pk_bf16_f32 v178, v180, v181
    v_mfma_f32_32x32x8_bf16 v[48:63], v[24:25], v[18:19], 0
    s_barrier
    v_cvt_pk_bf16_f32 v121, v122, v123
    v_cvt_pk_bf16_f32 v186, v188, v189
    v_cvt_pk_bf16_f32 v113, v114, v115
    v_exp_f32 v196, v196
    ds_read_b128 v[152:155], v3 offset:8192
    v_cvt_pk_bf16_f32 v122, v124, v125
    v_cvt_pk_bf16_f32 v123, v126, v127
    v_cvt_pk_bf16_f32 v115, v118, v119
    v_cvt_pk_bf16_f32 v114, v116, v117
    ds_read_b128 v[144:147], v1 offset:8192
    v_cvt_pk_bf16_f32 v200, v200, v201
    ds_read_b128 v[148:151], v2 offset:8192
    v_cvt_pk_bf16_f32 v201, v202, v203
    v_mfma_f32_32x32x16_bf16 v[48:63], v[168:171], v[112:115], v[48:63]
    ds_write_b16_d16_hi v14, v248 offset:336
    v_cvt_pk_bf16_f32 v252, v252, v253
    v_mfma_f32_16x16x16_bf16 v[100:103], v[20:21], v[18:19], 0
    v_cvt_pk_bf16_f32 v192, v192, v193
    v_cvt_pk_bf16_f32 v179, v182, v183
    ds_read_b128 v[156:159], v4 offset:8192
    v_mfma_f32_32x32x16_bf16 v[48:63], v[172:175], v[120:123], v[48:63]
    v_mfma_f32_16x16x32_bf16 v[96:99], v[20:23], v[176:179], v[96:99]
    s_setprio 2
    v_mfma_f32_16x16x32_bf16 v[100:103], v[20:23], v[112:115], v[100:103]
    v_mfma_f32_16x16x32_bf16 v[100:103], v[20:23], v[120:123], v[100:103]
    s_waitcnt lgkmcnt(3)
    v_mfma_f32_32x32x16_bf16 v[112:127], v[32:35], v[144:147], 0
    s_waitcnt lgkmcnt(2)
    v_mfma_f32_32x32x16_bf16 v[112:127], v[36:39], v[148:151], v[112:127]
    ds_read_b64_tr_b16 v[180:181], v8 offset:25600
    v_cvt_pk_bf16_f32 v193, v194, v195
    v_mfma_f32_32x32x16_bf16 v[112:127], v[40:43], v[152:155], v[112:127]
    ds_write_b16 v15, v252 offset:0
    s_waitcnt lgkmcnt(2)
    v_mfma_f32_32x32x16_bf16 v[112:127], v[44:47], v[156:159], v[112:127]
    v_cvt_pk_bf16_f32 v195, v198, v199
    v_exp_f32 v207, v207
    s_nop 8
    v_cvt_pk_bf16_f32 v249, v114, v115
    v_cvt_pk_bf16_f32 v251, v118, v119
    v_mfma_f32_32x32x16_bf16 v[208:223], v[240:243], v[176:179], v[208:223]
    v_cvt_pk_bf16_f32 v248, v112, v113
    v_cvt_pk_bf16_f32 v250, v116, v117
    v_cvt_pk_bf16_f32 v254, v124, v125
    ds_write_b16_d16_hi v15, v252 offset:272
    ds_read_b64_tr_b16 v[176:177], v8 offset:24576
    v_cvt_pk_bf16_f32 v252, v120, v121
    s_barrier
    v_mfma_f32_16x16x32_bf16 v[96:99], v[20:23], v[184:187], v[96:99]
    v_cvt_pk_bf16_f32 v253, v122, v123
    v_mfma_f32_32x32x16_bf16 v[32:47], v[248:251], v[160:163], 0
    v_cvt_pk_bf16_f32 v255, v126, v127
    v_mfma_f32_16x16x32_bf16 v[188:191], v[232:235], v[248:251], 0
    s_nop 0
    v_mfma_f32_32x32x16_bf16 v[32:47], v[252:255], v[164:167], v[32:47]
    v_mfma_f32_32x32x16_bf16 v[112:127], v[144:147], v[80:83], 0
    ds_read_b64_tr_b16 v[178:179], v8 offset:24832
    v_mfma_f32_32x32x16_bf16 v[112:127], v[148:151], v[84:87], v[112:127]
    v_exp_f32 v32, v32
    v_mfma_f32_16x16x32_bf16 v[188:191], v[236:239], v[252:255], v[188:191]
    v_exp_f32 v39, v39
    v_mfma_f32_32x32x16_bf16 v[112:127], v[152:155], v[88:91], v[112:127]
    v_exp_f32_e64 v41, v41
    v_cvt_pk_bf16_f32 v202, v204, v205
    v_exp_f32_e64 v189, v189
    v_mfma_f32_32x32x16_bf16 v[112:127], v[156:159], v[92:95], v[112:127]
    v_exp_f32 v188, v188
    s_setprio 0
    v_exp_f32 v34, v34
    v_exp_f32 v206, v206
    v_exp_f32_e64 v46, v46
    v_cvt_pk_bf16_f32 v188, v188, v189
    v_mfma_f32_32x32x16_bf16 v[208:223], v[244:247], v[184:187], v[208:223]
    v_cvt_pk_bf16_f32 v166, v124, v125
    v_cvt_pk_bf16_f32 v194, v196, v197
    v_exp_f32_e64 v40, v40
    v_cvt_pk_bf16_f32 v203, v206, v207
    ds_read_b128 v[196:199], v1 offset:0
    v_exp_f32 v44, v44
    v_exp_f32 v35, v35
    ds_read_b128 v[204:207], v2 offset:0
    v_exp_f32 v37, v37
    v_exp_f32 v33, v33
    v_cvt_pk_bf16_f32 v163, v118, v119
    v_cvt_pk_bf16_f32 v162, v116, v117
    ds_read_b128 v[232:235], v3 offset:0
    v_exp_f32 v36, v36
    v_exp_f32 v42, v42
    v_exp_f32_e64 v38, v38
    v_mfma_f32_16x16x32_bf16 v[100:103], v[20:23], v[192:195], v[100:103]
    v_cvt_pk_bf16_f32 v161, v114, v115
    ds_write_b16 v14, v188 offset:128
    v_cvt_pk_bf16_f32 v167, v126, v127
    v_cvt_pk_bf16_f32 v165, v122, v123
    v_cvt_pk_bf16_f32 v32, v32, v33
    v_cvt_pk_bf16_f32 v160, v112, v113
    v_mfma_f32_16x16x32_bf16 v[100:103], v[20:23], v[200:203], v[100:103]
    ds_write_b16_d16_hi v14, v188 offset:400
    ds_read_b64_tr_b16 v[190:191], v8 offset:27904
    v_cvt_pk_bf16_f32 v164, v120, v121
    v_mfma_f32_32x32x16_bf16 v[112:127], v[248:251], v[72:75], 0
    ds_read_b64_tr_b16 v[182:183], v8 offset:25856
    v_mfma_f32_32x32x16_bf16 v[112:127], v[252:255], v[76:79], v[112:127]
    ds_read_b64_tr_b16 v[186:187], v8 offset:26880
    v_cvt_pk_bf16_f32 v33, v34, v35
    v_exp_f32_e64 v45, v45
    ds_read_b64_tr_b16 v[188:189], v8 offset:27648
    ds_read_b64_tr_b16 v[184:185], v8 offset:26624
    v_cvt_pk_bf16_f32 v35, v38, v39
    v_cvt_pk_bf16_f32 v34, v36, v37
    s_nop 0
    s_nop 0
    v_mfma_f32_32x32x16_bf16 v[208:223], v[160:163], v[32:35], v[208:223]
    ds_read_b128 v[236:239], v1 offset:4096
    s_nop 0
    v_exp_f32 v115, v115
    v_exp_f32 v113, v113
    s_waitcnt lgkmcnt(10)
    v_mfma_f32_32x32x16_bf16 v[80:95], v[176:179], v[196:199], 0
    v_cvt_pk_bf16_f32 v40, v40, v41
    v_exp_f32_e64 v43, v43
    ds_read_b128 v[76:79], v2 offset:4096
    v_mfma_f32_32x32x16_bf16 v[48:63], v[240:243], v[192:195], v[48:63]
    v_cvt_pk_bf16_f32 v41, v42, v43
    ds_read_b128 v[72:75], v4 offset:0
    v_exp_f32 v122, v122
    s_waitcnt lgkmcnt(6)
    v_mfma_f32_32x32x16_bf16 v[80:95], v[180:183], v[204:207], v[80:95]
    v_exp_f32 v120, v120
    v_exp_f32 v112, v112
    v_exp_f32 v47, v47
    s_waitcnt lgkmcnt(3)
    v_mfma_f32_32x32x16_bf16 v[80:95], v[184:187], v[232:235], v[80:95]
    v_exp_f32 v119, v119
    v_exp_f32 v118, v118
    v_cvt_pk_bf16_f32 v42, v44, v45
    v_mfma_f32_32x32x16_bf16 v[48:63], v[244:247], v[200:203], v[48:63]
    v_cvt_pk_bf16_f32 v43, v46, v47
    v_exp_f32_e64 v114, v114
    ds_read_b128 v[44:47], v4 offset:4096
    v_mfma_f32_16x16x32_bf16 v[96:99], v[20:23], v[32:35], v[96:99]
    v_exp_f32 v125, v125
    v_mfma_f32_16x16x32_bf16 v[96:99], v[20:23], v[40:43], v[96:99]
    s_waitcnt lgkmcnt(1)
    v_mfma_f32_32x32x16_bf16 v[80:95], v[188:191], v[72:75], v[80:95]
    v_exp_f32 v117, v117
    v_exp_f32 v123, v123
    v_mfma_f32_32x32x16_bf16 v[208:223], v[164:167], v[40:43], v[208:223]
    v_exp_f32_e64 v126, v126
    v_cvt_pk_bf16_f32 v112, v112, v113
    s_setprio 3
    v_rcp_f32 v97, v96
    s_nop 5
    v_fmac_f32 v82, v210, v97
    v_fmac_f32 v84, v212, v97
    v_fmac_f32 v80, v208, v97
    v_mfma_f32_32x32x16_bf16 v[192:207], v[128:131], v[144:147], 0
    ds_read_b128 v[72:75], v3 offset:4096
    v_fmac_f32 v81, v209, v97
    v_cvt_pk_bf16_f32 v80, v80, v81
    v_fmac_f32 v86, v214, v97
    v_fmac_f32 v85, v213, v97
    v_fmac_f32 v90, v218, v97
    v_mfma_f32_32x32x16_bf16 v[192:207], v[132:135], v[148:151], v[192:207]
    v_fmac_f32 v88, v216, v97
    v_fmac_f32 v83, v211, v97
    v_fmac_f32 v94, v222, v97
    v_fmac_f32 v93, v221, v97
    v_fmac_f32 v92, v220, v97
    v_fmac_f32 v89, v217, v97
    v_mfma_f32_32x32x16_bf16 v[192:207], v[136:139], v[152:155], v[192:207]
    v_fmac_f32 v91, v219, v97
    v_cvt_pk_bf16_f32 v81, v82, v83
    v_fmac_f32 v87, v215, v97
    v_cvt_pk_bf16_f32 v83, v86, v87
    v_fmac_f32_e64 v95, v223, v97
    v_cvt_pk_bf16_f32 v87, v94, v95
    v_mfma_f32_32x32x16_bf16 v[192:207], v[140:143], v[156:159], v[192:207]
    v_cvt_pk_bf16_f32 v82, v84, v85
    v_pk_max_i16 v82, v82, 0
    v_pk_max_i16 v87, v87, 0
    v_cvt_pk_bf16_f32 v86, v92, v93
    v_pk_max_i16 v80, v80, 0
    v_cvt_pk_bf16_f32 v85, v90, v91
    v_mfma_f32_32x32x16_bf16 v[144:159], v[176:179], v[236:239], 0
    v_pk_max_i16 v83, v83, 0
    v_pk_max_i16 v81, v81, 0
    v_pk_max_i16 v86, v86, 0
    ds_write_b128 v9, v[80:83]
    v_cvt_pk_bf16_f32 v84, v88, v89
    v_pk_max_i16 v84, v84, 0
    v_pk_max_i16 v85, v85, 0
    ds_write_b128 v10, v[84:87]
    ds_read_b128 v[92:95], v11 offset:1024
    v_cvt_pk_bf16_f32 v113, v114, v115
    ds_read_b128 v[88:91], v11 offset:0
    v_exp_f32_e64 v121, v121
    ds_read_b128 v[32:35], v1 offset:8192
    v_mfma_f32_32x32x16_bf16 v[144:159], v[180:183], v[76:79], v[144:159]
    v_exp_f32 v116, v116
    s_nop 0
    v_cvt_pk_bf16_f32 v114, v116, v117
    v_cvt_pk_bf16_f32 v115, v118, v119
    v_cvt_pk_bf16_f32 v120, v120, v121
    v_cvt_pk_bf16_f32 v235, v198, v199
    v_mfma_f32_32x32x16_bf16 v[48:63], v[160:163], v[112:115], v[48:63]
    v_cvt_pk_bf16_f32 v121, v122, v123
    v_exp_f32 v127, v127
    v_mov_b32 v31, 0
    v_exp_f32 v124, v124
    s_waitcnt lgkmcnt(2)
    buffer_store_dwordx4 v[92:95], v12, s[24:27], 0 offen offset:2048 sc0 sc1 nt
    v_mfma_f32_32x32x16_bf16 v[144:159], v[184:187], v[72:75], v[144:159]
    ds_read_b128 v[40:43], v16 offset:128
    v_cvt_pk_bf16_f32 v123, v126, v127
    v_cvt_pk_bf16_f32 v233, v194, v195
    v_mfma_f32_16x16x32_bf16 v[100:103], v[20:23], v[112:115], v[100:103]
    v_cvt_pk_bf16_f32 v122, v124, v125
    ds_read_b128 v[80:83], v16 offset:0
    v_mfma_f32_32x32x16_bf16 v[144:159], v[188:191], v[44:47], v[144:159]
    ds_read_b128 v[220:223], v16 offset:64
    v_cvt_pk_bf16_f32 v232, v192, v193
    v_cvt_pk_bf16_f32 v211, v206, v207
    v_mov_b32 v38, 0x3f803f80
    v_cvt_pk_bf16_f32 v234, v196, v197
    v_mfma_f32_16x16x32_bf16 v[100:103], v[20:23], v[120:123], v[100:103]
    s_waitcnt lgkmcnt(4)
    buffer_store_dwordx4 v[88:91], v12, s[24:27], 0 offen offset:0 sc0 sc1 nt
    v_mfma_f32_32x32x16_bf16 v[48:63], v[164:167], v[120:123], v[48:63]
    s_nop 3
    v_rcp_f32 v101, v100
    v_cvt_pk_bf16_f32 v208, v200, v201
    v_mfma_f32_32x32x16_bf16 v[128:143], v[104:107], v[232:235], 0
    s_setprio 1
    ds_read_b128 v[212:215], v16 offset:160
    v_mov_b32 v39, 0x3f803f80
    v_cvt_pk_bf16_f32 v209, v202, v203
    v_fmac_f32 v148, v52, v101
    v_fmac_f32 v151, v55, v101
    v_fmac_f32 v144, v48, v101
    v_fmac_f32 v149, v53, v101
    v_fmac_f32 v146, v50, v101
    v_fmac_f32 v147, v51, v101
    v_fmac_f32 v155, v59, v101
    v_fmac_f32 v145, v49, v101
    v_fmac_f32 v157, v61, v101
    v_cvt_pk_bf16_f32 v144, v144, v145
    v_fmac_f32 v152, v56, v101
    v_cvt_pk_bf16_f32 v145, v146, v147
    v_fmac_f32_e64 v154, v58, v101
    v_mfma_f32_32x32x16_bf16 v[112:127], v[64:67], v[232:235], 0
    v_fmac_f32_e64 v153, v57, v101
    v_cvt_pk_bf16_f32 v210, v204, v205
    v_cvt_pk_bf16_f32 v146, v148, v149
    v_cvt_pk_bf16_f32 v148, v152, v153
    v_pk_max_i16 v145, v145, 0
    v_mfma_f32_32x32x16_bf16 v[128:143], v[108:111], v[208:211], v[128:143]
    v_fmac_f32_e64 v150, v54, v101
    v_pk_max_i16 v148, v148, 0
    v_fmac_f32_e64 v156, v60, v101
    v_cvt_pk_bf16_f32 v147, v150, v151
    v_pk_max_i16 v146, v146, 0
    v_cvt_pk_bf16_f32 v149, v154, v155
    v_mfma_f32_32x32x16_bf16 v[112:127], v[68:71], v[208:211], v[112:127]
    v_pk_max_i16 v149, v149, 0
    v_fmac_f32_e64 v159, v63, v101
    v_pk_max_i16 v144, v144, 0
    v_fmac_f32_e64 v158, v62, v101
    v_cvt_pk_bf16_f32 v151, v158, v159
    v_pk_max_i16 v147, v147, 0
    v_mfma_f32_32x32x16_bf16 v[44:59], v[248:251], v[232:235], 0
    ds_write_b128 v9, v[144:147]
    v_pk_max_i16 v151, v151, 0
    v_cvt_pk_bf16_f32 v150, v156, v157
    v_mfma_f32_16x16x32_bf16 v[216:219], v[224:227], v[232:235], 0
    s_setprio 3
    v_pk_max_i16 v150, v150, 0
    ds_write_b128 v10, v[148:151]
    ds_read_b128 v[152:155], v11 offset:0
    v_mfma_f32_32x32x16_bf16 v[44:59], v[252:255], v[208:211], v[44:59]
    s_waitcnt lgkmcnt(0)
    buffer_store_dwordx4 v[152:155], v12, s[24:27], s39 offen offset:0 sc0 sc1 nt
    ds_read_b64 v[98:99], v16 offset:192
    v_exp_f32_e64 v124, v124
    ds_read_b128 v[76:79], v16 offset:96
    v_mfma_f32_16x16x32_bf16 v[216:219], v[228:231], v[208:211], v[216:219]
    ds_read_b128 v[200:203], v2 offset:8192
    ds_read_b128 v[156:159], v11 offset:1024
    ds_read_b128 v[196:199], v16 offset:32
    s_setprio 0
    v_exp_f32 v49, v49
    v_exp_f32 v119, v119
    v_exp_f32 v130, v130
    v_exp_f32 v140, v140
    v_exp_f32 v125, v125
    v_exp_f32_e64 v45, v45
    v_max3_u32 v17, v96, v97, v17
    v_exp_f32 v44, v44
    s_waitcnt lgkmcnt(1)
    buffer_store_dwordx4 v[156:159], v12, s[24:27], s39 offen offset:2048 sc0 sc1 nt
    v_exp_f32 v122, v122
    v_exp_f32 v47, v47
    v_exp_f32 v129, v129
    v_exp_f32 v54, v54
    v_exp_f32 v143, v143
    v_exp_f32 v51, v51
    v_exp_f32 v57, v57
    v_exp_f32 v123, v123
    v_exp_f32 v134, v134
    v_exp_f32 v120, v120
    v_exp_f32 v217, v217
    v_exp_f32 v112, v112
    ds_read_b128 v[72:75], v4 offset:8192
    v_exp_f32 v216, v216
    v_exp_f32 v121, v121
    ds_read_b128 v[84:87], v3 offset:8192
    v_exp_f32 v128, v128
    v_mov_b32 v36, 0x3f803f80
    v_exp_f32 v46, v46
    v_exp_f32 v133, v133
    v_exp_f32 v114, v114
    v_exp_f32_e64 v113, v113
    v_mfma_f32_32x32x16_bf16 v[224:239], v[176:179], v[32:35], 0
    v_exp_f32_e64 v136, v136
    v_mov_b32 v37, 0x3f803f80
    v_cvt_pk_bf16_f32 v44, v44, v45
    v_exp_f32 v132, v132
    v_mfma_f32_32x32x16_bf16 v[224:239], v[180:183], v[200:203], v[224:239]
    v_exp_f32 v59, v59
    v_exp_f32_e64 v137, v137
    v_cvt_pk_bf16_f32 v18, v216, v217
    v_cvt_pk_bf16_f32 v128, v128, v129
    v_mfma_f32_16x16x16_bf16 v[192:195], v[98:99], v[24:25], 0
    v_exp_f32_e64 v127, v127
    v_cvt_pk_bf16_f32 v120, v120, v121
    v_mfma_f32_16x16x16_bf16 v[88:91], v[98:99], v[30:31], 0
    v_exp_f32_e64 v116, v116
    v_cvt_pk_bf16_f32 v45, v46, v47
    v_mfma_f32_16x16x32_bf16 v[192:195], v[80:83], v[168:171], v[192:195]
    v_exp_f32 v131, v131
    v_mfma_f32_16x16x32_bf16 v[88:91], v[80:83], v[36:39], v[88:91]
    v_exp_f32 v138, v138
    v_mfma_f32_16x16x16_bf16 v[204:207], v[20:21], v[18:19], 0
    v_exp_f32 v53, v53
    s_waitcnt lgkmcnt(2)
    v_mfma_f32_16x16x32_bf16 v[88:91], v[196:199], v[36:39], v[88:91]
    v_cvt_pk_bf16_f32 v129, v130, v131
    v_cvt_pk_bf16_f32 v136, v136, v137
    v_mfma_f32_16x16x32_bf16 v[88:91], v[220:223], v[36:39], v[88:91]
    v_exp_f32 v52, v52
    v_mfma_f32_16x16x32_bf16 v[88:91], v[76:79], v[36:39], v[88:91]
    v_exp_f32 v126, v126
    v_mfma_f32_16x16x32_bf16 v[192:195], v[196:199], v[172:175], v[192:195]
    v_exp_f32 v139, v139
    s_waitcnt lgkmcnt(0)
    v_mfma_f32_32x32x16_bf16 v[224:239], v[184:187], v[84:87], v[224:239]
    v_exp_f32_e64 v135, v135
    v_cvt_pk_bf16_f32 v112, v112, v113
    v_cvt_pk_bf16_f32 v52, v52, v53
    v_cvt_pk_bf16_f32 v130, v132, v133
    v_cvt_pk_bf16_f32 v131, v134, v135
    v_mfma_f32_32x32x8_bf16 v[144:159], v[24:25], v[18:19], 0
    v_exp_f32 v58, v58
    v_exp_f32 v48, v48
    v_exp_f32 v141, v141
    v_mfma_f32_16x16x32_bf16 v[192:195], v[220:223], v[240:243], v[192:195]
    v_exp_f32 v142, v142
    v_mfma_f32_16x16x32_bf16 v[88:91], v[40:43], v[36:39], v[88:91]
    v_exp_f32_e64 v56, v56
    v_mfma_f32_32x32x16_bf16 v[224:239], v[188:191], v[72:75], v[224:239]
    v_cvt_pk_bf16_f32 v137, v138, v139
    v_cvt_pk_bf16_f32 v139, v142, v143
    v_max3_u32 v17, v100, v101, v17
    v_exp_f32 v50, v50
    v_exp_f32 v55, v55
    v_mfma_f32_16x16x32_bf16 v[204:207], v[20:23], v[128:131], v[204:207]
    v_cvt_pk_bf16_f32 v121, v122, v123
    v_exp_f32_e64 v115, v115
    v_mfma_f32_32x32x16_bf16 v[144:159], v[168:171], v[128:131], v[144:159]
    v_cvt_pk_bf16_f32 v113, v114, v115
    v_cvt_pk_bf16_f32 v122, v124, v125
    v_cvt_pk_bf16_f32 v53, v54, v55
    v_cvt_pk_bf16_f32 v138, v140, v141
    v_exp_f32_e64 v117, v117
    v_mfma_f32_16x16x32_bf16 v[88:91], v[212:215], v[36:39], v[88:91]
    v_exp_f32_e64 v118, v118
    v_mfma_f32_32x32x16_bf16 v[144:159], v[172:175], v[136:139], v[144:159]
    v_cvt_pk_bf16_f32 v114, v116, v117
    v_cvt_pk_bf16_f32 v54, v56, v57
    v_cvt_pk_bf16_f32 v47, v50, v51
    v_cvt_pk_bf16_f32 v46, v48, v49
    v_cvt_pk_bf16_f32 v115, v118, v119
    v_cvt_pk_bf16_f32 v123, v126, v127
    v_mfma_f32_16x16x32_bf16 v[192:195], v[76:79], v[244:247], v[192:195]
    v_rcp_f32_e64 v91, v89
    v_mfma_f32_16x16x32_bf16 v[204:207], v[20:23], v[136:139], v[204:207]
    v_mfma_f32_16x16x32_bf16 v[204:207], v[20:23], v[112:115], v[204:207]
    v_mfma_f32_16x16x32_bf16 v[192:195], v[40:43], v[160:163], v[192:195]
    v_cvt_pk_bf16_f32 v55, v58, v59
    v_mfma_f32_32x32x16_bf16 v[144:159], v[240:243], v[112:115], v[144:159]
    v_mfma_f32_16x16x32_bf16 v[204:207], v[20:23], v[120:123], v[204:207]
    v_mfma_f32_16x16x32_bf16 v[204:207], v[20:23], v[44:47], v[204:207]
    v_mfma_f32_16x16x32_bf16 v[204:207], v[20:23], v[52:55], v[204:207]
    v_mfma_f32_32x32x16_bf16 v[144:159], v[244:247], v[120:123], v[144:159]
    v_mfma_f32_32x32x16_bf16 v[144:159], v[160:163], v[44:47], v[144:159]
    v_rcp_f32 v90, v88
    v_rcp_f32 v205, v204
    v_mfma_f32_32x32x16_bf16 v[144:159], v[164:167], v[52:55], v[144:159]
    s_nop 11
    v_fmac_f32 v225, v145, v205
    ds_read_b64 v[102:103], v7 offset:4096
    v_mfma_f32_16x16x32_bf16 v[192:195], v[212:215], v[164:167], v[192:195]
    v_fmac_f32 v229, v149, v205
    v_fmac_f32 v227, v147, v205
    v_fmac_f32 v224, v144, v205
    v_fmac_f32 v230, v150, v205
    v_cvt_pk_bf16_f32 v224, v224, v225
    v_fmac_f32 v236, v156, v205
    s_setprio 1
    v_fmac_f32 v231, v151, v205
    v_fmac_f32 v238, v158, v205
    v_fmac_f32_e64 v226, v146, v205
    v_cvt_pk_bf16_f32 v225, v226, v227
    v_fmac_f32 v232, v152, v205
    v_fmac_f32 v239, v159, v205
    v_cvt_pk_bf16_f32 v227, v230, v231
    v_fmac_f32_e64 v235, v155, v205
    v_pk_max_i16 v225, v225, 0
    v_fmac_f32 v233, v153, v205
    v_fmac_f32 v228, v148, v205
    v_fmac_f32_e64 v237, v157, v205
    v_pk_max_i16 v227, v227, 0
    v_cvt_pk_bf16_f32 v226, v228, v229
    v_pk_max_i16 v224, v224, 0
    v_pk_max_i16 v226, v226, 0
    v_cvt_pk_bf16_f32 v228, v232, v233
    v_fmac_f32 v234, v154, v205
    v_cvt_pk_bf16_f32 v231, v238, v239
    s_waitcnt lgkmcnt(0)
    v_fma_f32 v193, v193, v91, v103
    ds_write_b128 v9, v[224:227]
    v_fma_f32 v192, v192, v90, v102
    v_cvt_pk_bf16_f32 v230, v236, v237
    v_cvt_pk_bf16_f32 v229, v234, v235
    v_cvt_pk_bf16_f32 v192, v192, v193
    v_pk_max_i16 v192, v192, 0
    v_pk_max_i16 v229, v229, 0
    v_pk_max_i16 v230, v230, 0
    v_pk_max_i16 v228, v228, 0
    v_pk_max_i16 v231, v231, 0
    ds_write_b128 v10, v[228:231]
    ds_read_b128 v[232:235], v11 offset:0
    buffer_store_short_d16_hi v192, v13, s[24:27], 0 offen offset:128 sc0 sc1 nt
    ds_read_b128 v[236:239], v11 offset:1024
    buffer_store_short v192, v13, s[24:27], 0 offen sc0 sc1 nt
    s_waitcnt lgkmcnt(1)
    buffer_store_dwordx4 v[232:235], v12, s[24:27], s40 offen offset:0 sc0 sc1 nt
    s_waitcnt lgkmcnt(0)
    buffer_store_dwordx4 v[236:239], v12, s[24:27], s40 offen offset:2048 sc0 sc1 nt
    v_max3_u32 v17, v88, v90, v17
    v_max3_u32 v17, v89, v91, v17
    v_max3_u32 v17, v204, v205, v17
L_loend:
    s_branch L_fin
L_hi1:
    v_bfe_u32 v240, v0, 3, 1
    v_and_b32 v241, 1, v0
    v_lshl_add_u32 v241, v240, 1, v241
    v_lshl_add_u32 v240, v27, 9, s48
    v_lshl_add_u32 v6, v241, 4, v240
    v_add_u32 v5, 2048, v6
    v_add_u32_e64 v240, v27, v241
    v_lshl_add_u32 v240, v240, 4, s49
    v_lshl_add_u32 v16, v241, 8, v240
    v_lshrrev_b32 v241, 2, v0
    v_xor_b32 v241, v241, v0
    v_and_b32 v242, 4, v241
    v_cmp_eq_u32 vcc, 0, v242
    v_mov_b32 v240, 0x3f803f80
    s_nop 0
    v_cndmask_b32 v20, 0, v240, vcc
    v_and_or_b32 v241, v0, 2, v242
    v_cmp_eq_u32 vcc, 0, v241
    v_mov_b32 v241, 96384
    s_nop 0
    v_cndmask_b32 v6, v241, v6, vcc
    v_cndmask_b32 v5, v241, v5, vcc
    v_cndmask_b32 v16, v241, v16, vcc
    v_mov_b32 v21, v20
    v_mov_b32 v22, v20
    v_mov_b32 v23, v20
    v_and_b32_e64 v243, 31, v0
    v_lshl_add_u32 v240, v243, 4, s52
    v_lshl_add_u32 v7, v27, 3, v240
    v_mov_b32 v17, 0
    v_and_b32 v240, 0x13, v0
    v_and_b32_e64 v241, 4, v0
    v_lshl_add_u32 v240, v241, 1, v240
    v_bfe_u32 v241, v0, 3, 1
    v_lshl_add_u32 v240, v241, 2, v240
    v_lshlrev_b32_e64 v240, 1, v240
    v_lshl_add_u32 v242, v27, 8, v240
    v_add_u32_e64 v242, s50, v242
    v_add_u32 v13, 12288, v242
    v_lshl_add_u32 v242, v27, 9, s49
    v_lshl_add_u32 v242, v27, 5, v242
    v_add_u32 v14, v242, v240
    v_and_b32 v240, 3, v0
    v_lshl_add_u32 v240, v241, 3, v240
    v_lshlrev_b32_e64 v240, 1, v240
    v_add_u32 v240, 192, v240
    v_and_b32 v241, 0x14, v0
    v_cmp_eq_u32 vcc, 0, v241
    v_mov_b32 v241, 240
    s_nop 0
    v_cndmask_b32 v240, v241, v240, vcc
    v_add_u32 v15, v242, v240
    v_bfe_u32 v240, v0, 1, 2
    v_xor_b32 v240, v240, v27
    v_lshl_add_u32 v240, v240, 4, s36
    v_and_b32_e64 v243, 31, v0
    v_lshl_add_u32 v9, v243, 6, v240
    v_xor_b32 v10, 32, v9
    v_lshrrev_b32 v240, 3, v0
    v_xor_b32 v240, v240, v0
    v_and_b32 v240, 3, v240
    v_lshl_add_u32 v240, v240, 4, s36
    v_bfe_u32 v241, v0, 2, 4
    v_lshl_add_u32 v11, v241, 6, v240
    v_and_b32_e64 v240, 3, v0
    v_lshl_add_u32 v240, v240, 4, s50
    v_lshl_add_u32 v12, v241, 7, v240
    s_lshl_b32 s46, s34, 11
    s_lshl_b32 s47, s33, 8
    s_add_u32 s46, s46, s47
    s_add_u32 s46, s46, 85504
    v_and_b32 v241, 15, v0
    v_lshl_add_u32 v241, v241, 4, s46
    v_and_b32_e64 v242, 48, v0
    v_lshl_add_u32 v255, v242, 5, v241
    v_add_u32 v249, 123648, v248
    s_waitcnt lgkmcnt(0)
L_hi:
    s_add_u32 m0, s42, 4096
    s_waitcnt vmcnt(4)
    ds_read_b128 v[216:219], v248 offset:0
    v_add_u32 v245, 4096, v245
    ds_read_b128 v[40:43], v248 offset:1024
    s_waitcnt vmcnt(2)
    s_barrier
    s_waitcnt lgkmcnt(1)
    v_lshlrev_b32 v211, 16, v218
    s_waitcnt lgkmcnt(0)
    v_lshlrev_b32 v82, 16, v41
    v_lshlrev_b32_e64 v183, 16, v40
    v_add_u32 v246, 4096, v246
    v_and_b32 v83, 0xffff0000, v218
    v_lshlrev_b32_e64 v250, 16, v219
    v_and_b32 v209, 0xffff0000, v216
    v_and_b32 v80, 0xffff0000, v40
    v_and_b32 v208, 0xffff0000, v43
    v_and_b32 v29, 0xffff0000, v41
    v_mul_f32 v80, s45, v80
    v_lshlrev_b32 v210, 16, v43
    v_lshlrev_b32_e64 v181, 16, v42
    v_and_b32 v182, 0xffff0000, v217
    v_mul_f32_e64 v208, s45, v208
    global_load_lds_dwordx4 v245, s[4:5] nt
    v_mul_f32 v209, s45, v209
    v_mul_f32 v83, s45, v83
    v_mul_f32 v250, s45, v250
    v_mul_f32 v82, s45, v82
    v_mul_f32 v182, s45, v182
    v_mul_f32 v183, s45, v183
    v_mul_f32 v211, s45, v211
    v_lshlrev_b32 v180, 16, v216
    ds_read_b64_tr_b16 v[68:69], v8 offset:17408
    v_lshlrev_b32 v81, 16, v217
    v_mul_f32 v81, s45, v81
    v_mul_f32_e64 v210, s45, v210
    v_and_b32 v244, 0xffff0000, v219
    ds_read_b64_tr_b16 v[44:45], v253 offset:2048
    v_mul_f32_e64 v29, s45, v29
    v_cvt_pk_bf16_f32 v43, v210, v208
    v_mul_f32_e64 v244, s45, v244
    v_and_b32 v247, 0xffff0000, v42
    ds_read_b128 v[32:35], v254
    global_load_lds_dwordx4 v246, s[4:5] offset:1024 nt
    v_cvt_pk_bf16_f32 v218, v211, v83
    ds_read_b64_tr_b16 v[50:51], v26 offset:8448
    v_mul_f32_e64 v180, s45, v180
    ds_read_b64_tr_b16 v[64:65], v8 offset:16384
    ds_read_b64_tr_b16 v[212:213], v253 offset:0
    v_cvt_pk_bf16_f32 v216, v180, v209
    v_mul_f32_e64 v181, s45, v181
    ds_read_b64_tr_b16 v[214:215], v253 offset:256
    v_cvt_pk_bf16_f32 v41, v82, v29
    v_cvt_pk_bf16_f32 v219, v250, v244
    v_cvt_pk_bf16_f32 v40, v183, v80
    ds_read_b128 v[220:223], v252
    ds_read_b64_tr_b16 v[60:61], v26 offset:11264
    s_add_u32 m0, s42, 8192
    ds_read_b64_tr_b16 v[56:57], v26 offset:10240
    v_mul_f32 v247, s45, v247
    v_cvt_pk_bf16_f32 v217, v81, v182
    ds_read_b64_tr_b16 v[46:47], v253 offset:2304
    s_waitcnt lgkmcnt(4)
    v_mfma_f32_16x16x32_bf16 v[240:243], v[32:35], v[212:215], 0
    ds_read_b64_tr_b16 v[78:79], v8 offset:19712
    ds_read_b64_tr_b16 v[58:59], v26 offset:10496
    v_cvt_pk_bf16_f32 v42, v181, v247
    ds_write_b128 v249, v[216:219] offset:0
    s_waitcnt lgkmcnt(3)
    v_mfma_f32_16x16x32_bf16 v[240:243], v[220:223], v[44:47], v[240:243]
    s_nop 7
    ds_write_b128 v255, v[240:243] offset:0
    ds_write_b128 v249, v[40:43] offset:1024
    ds_read_b64_tr_b16 v[52:53], v26 offset:9216
    s_setprio 2
    ds_read_b64_tr_b16 v[66:67], v8 offset:16640
    ds_read_b64_tr_b16 v[62:63], v26 offset:11520
    ds_read_b64_tr_b16 v[72:73], v8 offset:18432
    ds_read_b64_tr_b16 v[74:75], v8 offset:18688
    ds_read_b64_tr_b16 v[54:55], v26 offset:9472
    s_waitcnt vmcnt(2)
    ds_read_b64_tr_b16 v[76:77], v8 offset:19456
    v_add_u32 v245, 4096, v245
    ds_read_b64_tr_b16 v[70:71], v8 offset:17664
    ds_read_b64_tr_b16 v[48:49], v26 offset:8192
    s_waitcnt lgkmcnt(9)
    s_barrier
    ds_read_b128 v[204:207], v1 offset:0
    ds_read_b128 v[32:35], v254
    ds_read_b128 v[84:87], v2 offset:0
    ds_read_b64_tr_b16 v[96:97], v28 offset:0
    ds_read_b64_tr_b16 v[106:107], v28 offset:2304
    ds_read_b64_tr_b16 v[102:103], v28 offset:1280
    ds_read_b128 v[176:179], v4 offset:0
    ds_read_b64_tr_b16 v[98:99], v28 offset:256
    ds_read_b64_tr_b16 v[100:101], v28 offset:1024
    s_waitcnt lgkmcnt(8)
    v_mfma_f32_32x32x16_bf16 v[184:199], v[204:207], v[64:67], 0
    ds_read_b128 v[200:203], v3 offset:0
    ds_read_b64_tr_b16 v[104:105], v28 offset:2048
    v_mfma_f32_32x32x16_bf16 v[112:127], v[48:51], v[204:207], 0
    ds_read_b64_tr_b16 v[110:111], v28 offset:3328
    s_waitcnt lgkmcnt(9)
    v_mfma_f32_32x32x16_bf16 v[112:127], v[52:55], v[84:87], v[112:127]
    ds_read_b64_tr_b16 v[108:109], v28 offset:3072
    s_waitcnt lgkmcnt(5)
    v_mfma_f32_32x32x16_bf16 v[144:159], v[96:99], v[204:207], 0
    v_mfma_f32_32x32x16_bf16 v[184:199], v[84:87], v[68:71], v[184:199]
    ds_read_b128 v[224:227], v5 offset:0
    s_waitcnt lgkmcnt(4)
    v_mfma_f32_32x32x16_bf16 v[112:127], v[56:59], v[200:203], v[112:127]
    ds_read_b128 v[232:235], v6 offset:0
    v_mfma_f32_32x32x16_bf16 v[112:127], v[60:63], v[176:179], v[112:127]
    ds_read_b64 v[30:31], v7
    ds_read_b128 v[228:231], v5 offset:256
    v_mfma_f32_32x32x16_bf16 v[144:159], v[100:103], v[84:87], v[144:159]
    s_waitcnt lgkmcnt(6)
    v_mfma_f32_32x32x16_bf16 v[144:159], v[104:107], v[200:203], v[144:159]
    v_cvt_pk_bf16_f32 v128, v112, v113
    v_add_u32 v246, 4096, v246
    v_mfma_f32_32x32x16_bf16 v[184:199], v[200:203], v[72:75], v[184:199]
    ds_read_b128 v[236:239], v6 offset:256
    v_cvt_pk_bf16_f32 v130, v116, v117
    s_waitcnt lgkmcnt(5)
    v_mfma_f32_32x32x16_bf16 v[144:159], v[108:111], v[176:179], v[144:159]
    v_cvt_pk_bf16_f32 v129, v114, v115
    v_cvt_pk_bf16_f32 v131, v118, v119
    s_waitcnt lgkmcnt(3)
    s_nop 0
    v_mfma_f32_16x16x32_bf16 v[92:95], v[232:235], v[128:131], 0
    v_cvt_pk_bf16_f32 v134, v124, v125
    v_mfma_f32_16x16x32_bf16 v[36:39], v[232:235], v[224:227], 0
    v_cvt_pk_bf16_f32 v138, v148, v149
    v_cvt_pk_bf16_f32 v137, v146, v147
    v_mfma_f32_32x32x16_bf16 v[184:199], v[176:179], v[76:79], v[184:199]
    v_cvt_pk_bf16_f32 v139, v150, v151
    v_cvt_pk_bf16_f32 v132, v120, v121
    v_cvt_pk_bf16_f32 v141, v154, v155
    v_cvt_pk_bf16_f32 v136, v144, v145
    v_cvt_pk_bf16_f32 v140, v152, v153
    v_cvt_pk_bf16_f32 v142, v156, v157
    v_cvt_pk_bf16_f32 v143, v158, v159
    v_mfma_f32_16x16x32_bf16 v[88:91], v[224:227], v[136:139], 0
    v_cvt_pk_bf16_f32 v133, v122, v123
    s_waitcnt lgkmcnt(1)
    v_mfma_f32_16x16x32_bf16 v[88:91], v[228:231], v[140:143], v[88:91]
    v_mfma_f32_32x32x16_bf16 v[160:175], v[128:131], v[136:139], 0
    v_cvt_pk_bf16_f32 v135, v126, v127
    s_nop 1
    v_exp_f32 v88, v88
    s_waitcnt lgkmcnt(0)
    v_mfma_f32_16x16x32_bf16 v[36:39], v[236:239], v[228:231], v[36:39]
    global_load_lds_dwordx4 v245, s[4:5] nt
    v_mfma_f32_32x32x16_bf16 v[160:175], v[132:135], v[140:143], v[160:175]
    s_barrier
    v_mfma_f32_16x16x32_bf16 v[92:95], v[236:239], v[132:135], v[92:95]
    v_exp_f32 v36, v36
    v_cvt_pk_bf16_f32 v24, v30, v31
    v_exp_f32_e64 v160, v160
    global_load_lds_dwordx4 v246, s[4:5] offset:1024 nt
    v_cvt_pk_bf16_f32 v246, v196, v197
    ds_read_b128 v[44:47], v252
    v_exp_f32 v93, v93
    v_exp_f32 v37, v37
    v_exp_f32 v173, v173
    v_exp_f32 v161, v161
    v_cvt_pk_bf16_f32 v240, v184, v185
    v_cvt_pk_bf16_f32 v160, v160, v161
    v_exp_f32_e64 v171, v171
    v_cvt_pk_bf16_f32 v243, v190, v191
    v_cvt_pk_bf16_f32 v241, v186, v187
    v_exp_f32_e64 v170, v170
    v_cvt_pk_bf16_f32 v36, v36, v37
    v_cvt_pk_bf16_f32 v244, v192, v193
    v_exp_f32 v174, v174
    v_exp_f32 v172, v172
    v_exp_f32 v92, v92
    v_exp_f32 v162, v162
    v_exp_f32 v169, v169
    v_exp_f32 v167, v167
    v_exp_f32 v165, v165
    v_exp_f32 v168, v168
    v_exp_f32_e64 v163, v163
    ds_read_b64_tr_b16 v[42:43], v253 offset:8448
    v_exp_f32 v164, v164
    v_exp_f32 v89, v89
    v_cvt_pk_bf16_f32 v92, v92, v93
    ds_write_b16 v14, v92 offset:0
    v_exp_f32_e64 v175, v175
    v_exp_f32_e64 v166, v166
    v_cvt_pk_bf16_f32 v168, v168, v169
    v_cvt_pk_bf16_f32 v242, v188, v189
    v_cvt_pk_bf16_f32 v169, v170, v171
    ds_read_b64_tr_b16 v[112:113], v253 offset:10240
    v_cvt_pk_bf16_f32 v245, v194, v195
    v_cvt_pk_bf16_f32 v18, v88, v89
    ds_write_b16_d16_hi v15, v36 offset:272
    ds_read_b64_tr_b16 v[114:115], v253 offset:10496
    v_cvt_pk_bf16_f32 v161, v162, v163
    v_cvt_pk_bf16_f32 v247, v198, v199
    v_cvt_pk_bf16_f32 v163, v166, v167
    v_cvt_pk_bf16_f32 v171, v174, v175
    v_cvt_pk_bf16_f32 v170, v172, v173
    v_cvt_pk_bf16_f32 v162, v164, v165
    ds_read_b64_tr_b16 v[40:41], v253 offset:8192
    ds_write_b16_d16_hi v14, v92 offset:272
    s_waitcnt vmcnt(2)
    s_barrier
    v_mfma_f32_32x32x16_bf16 v[208:223], v[240:243], v[160:163], 0
    ds_read_b128 v[80:83], v1 offset:4096
    ds_read_b128 v[116:119], v2 offset:4096
    v_mfma_f32_16x16x32_bf16 v[248:251], v[20:23], v[160:163], 0
    v_mfma_f32_16x16x32_bf16 v[248:251], v[20:23], v[168:171], v[248:251]
    s_waitcnt lgkmcnt(3)
    v_mfma_f32_16x16x32_bf16 v[84:87], v[32:35], v[40:43], 0
    v_mfma_f32_16x16x16_bf16 v[248:251], v[20:21], v[18:19], v[248:251]
    ds_read_b128 v[124:127], v4 offset:4096
    v_mfma_f32_16x16x32_bf16 v[84:87], v[44:47], v[112:115], v[84:87]
    ds_read_b128 v[120:123], v3 offset:4096
    v_mfma_f32_32x32x16_bf16 v[208:223], v[244:247], v[168:171], v[208:223]
    s_waitcnt lgkmcnt(3)
    v_mfma_f32_32x32x16_bf16 v[144:159], v[96:99], v[80:83], 0
    s_waitcnt lgkmcnt(2)
    v_mfma_f32_32x32x16_bf16 v[144:159], v[100:103], v[116:119], v[144:159]
    v_mfma_f32_32x32x16_bf16 v[176:191], v[48:51], v[80:83], 0
    v_mfma_f32_32x32x16_bf16 v[176:191], v[52:55], v[116:119], v[176:191]
    s_waitcnt lgkmcnt(0)
    v_mfma_f32_32x32x16_bf16 v[176:191], v[56:59], v[120:123], v[176:191]
    v_mfma_f32_32x32x16_bf16 v[176:191], v[60:63], v[124:127], v[176:191]
    v_mfma_f32_32x32x16_bf16 v[144:159], v[104:107], v[120:123], v[144:159]
    ds_write_b128 v255, v[84:87] offset:4096
    v_mfma_f32_32x32x16_bf16 v[192:207], v[80:83], v[64:67], 0
    v_mfma_f32_32x32x16_bf16 v[144:159], v[108:111], v[124:127], v[144:159]
    ds_write_b16 v15, v36 offset:0
    v_mfma_f32_32x32x16_bf16 v[192:207], v[116:119], v[68:71], v[192:207]
    v_cvt_pk_bf16_f32 v30, v176, v177
    v_cvt_pk_bf16_f32 v33, v182, v183
    v_cvt_pk_bf16_f32 v32, v180, v181
    v_cvt_pk_bf16_f32 v40, v144, v145
    v_cvt_pk_bf16_f32 v44, v152, v153
    v_mfma_f32_32x32x16_bf16 v[192:207], v[120:123], v[72:75], v[192:207]
    v_cvt_pk_bf16_f32 v46, v156, v157
    v_cvt_pk_bf16_f32 v31, v178, v179
    v_cvt_pk_bf16_f32 v36, v184, v185
    v_cvt_pk_bf16_f32 v43, v150, v151
    v_cvt_pk_bf16_f32 v39, v190, v191
    v_mfma_f32_32x32x16_bf16 v[192:207], v[124:127], v[76:79], v[192:207]
    v_cvt_pk_bf16_f32 v45, v154, v155
    v_mfma_f32_16x16x32_bf16 v[172:175], v[232:235], v[30:33], 0
    v_mfma_f32_32x32x16_bf16 v[80:95], v[30:33], v[136:139], 0
    v_cvt_pk_bf16_f32 v42, v148, v149
    v_cvt_pk_bf16_f32 v37, v186, v187
    v_cvt_pk_bf16_f32 v41, v146, v147
    v_cvt_pk_bf16_f32 v38, v188, v189
    v_cvt_pk_bf16_f32 v47, v158, v159
    s_waitcnt lgkmcnt(1)
    s_barrier
    v_mfma_f32_32x32x16_bf16 v[176:191], v[128:131], v[40:43], 0
    v_mfma_f32_16x16x32_bf16 v[168:171], v[224:227], v[40:43], 0
    v_mfma_f32_16x16x32_bf16 v[172:175], v[236:239], v[36:39], v[172:175]
    v_mfma_f32_32x32x16_bf16 v[176:191], v[132:135], v[44:47], v[176:191]
    v_cvt_pk_bf16_f32 v166, v204, v205
    v_cvt_pk_bf16_f32 v165, v202, v203
    s_nop 0
    v_exp_f32 v172, v172
    v_mfma_f32_32x32x16_bf16 v[80:95], v[36:39], v[140:143], v[80:95]
    v_cvt_pk_bf16_f32 v161, v194, v195
    s_setprio 1
    v_cvt_pk_bf16_f32 v160, v192, v193
    v_exp_f32 v191, v191
    v_cvt_pk_bf16_f32 v162, v196, v197
    v_cvt_pk_bf16_f32 v163, v198, v199
    v_exp_f32 v189, v189
    v_mfma_f32_16x16x32_bf16 v[168:171], v[228:231], v[44:47], v[168:171]
    v_exp_f32 v187, v187
    v_exp_f32 v95, v95
    v_exp_f32 v185, v185
    v_exp_f32 v177, v177
    v_exp_f32 v83, v83
    v_exp_f32 v173, v173
    v_exp_f32 v82, v82
    v_exp_f32 v180, v180
    v_exp_f32 v93, v93
    v_exp_f32 v81, v81
    v_exp_f32 v168, v168
    v_exp_f32_e64 v184, v184
    v_cvt_pk_bf16_f32 v167, v206, v207
    v_exp_f32 v169, v169
    v_exp_f32 v181, v181
    v_exp_f32_e64 v186, v186
    v_cvt_pk_bf16_f32 v164, v200, v201
    v_mfma_f32_32x32x16_bf16 v[192:207], v[30:33], v[40:43], 0
    v_exp_f32 v89, v89
    v_exp_f32 v188, v188
    v_exp_f32 v190, v190
    s_waitcnt vmcnt(0)
    v_mfma_f32_32x32x16_bf16 v[192:207], v[36:39], v[44:47], v[192:207]
    v_exp_f32 v80, v80
    v_exp_f32 v176, v176
    v_cvt_pk_bf16_f32 v184, v184, v185
    v_mfma_f32_32x32x8_bf16 v[208:223], v[24:25], v[18:19], v[208:223]
    s_barrier
    ds_read_b128 v[124:127], v4 offset:8192
    v_cvt_pk_bf16_f32 v185, v186, v187
    v_exp_f32 v178, v178
    v_cvt_pk_bf16_f32 v80, v80, v81
    v_exp_f32 v182, v182
    v_exp_f32 v88, v88
    v_exp_f32 v179, v179
    v_exp_f32 v193, v193
    v_cvt_pk_bf16_f32 v176, v176, v177
    v_cvt_pk_bf16_f32 v177, v178, v179
    v_exp_f32 v183, v183
    v_exp_f32 v192, v192
    v_cvt_pk_bf16_f32 v18, v168, v169
    ds_read_b128 v[120:123], v3 offset:8192
    v_exp_f32_e64 v199, v199
    ds_read_b128 v[112:115], v1 offset:8192
    v_mfma_f32_32x32x8_bf16 v[144:159], v[24:25], v[18:19], 0
    ds_read_b128 v[116:119], v2 offset:8192
    v_cvt_pk_bf16_f32 v179, v182, v183
    v_exp_f32_e64 v91, v91
    v_mfma_f32_16x16x16_bf16 v[252:255], v[20:21], v[18:19], 0
    v_cvt_pk_bf16_f32 v178, v180, v181
    v_cvt_pk_bf16_f32 v187, v190, v191
    s_nop 0
    s_nop 1
    v_mfma_f32_16x16x32_bf16 v[252:255], v[20:23], v[176:179], v[252:255]
    v_mfma_f32_32x32x16_bf16 v[144:159], v[240:243], v[176:179], v[144:159]
    v_exp_f32_e64 v85, v85
    v_cvt_pk_bf16_f32 v186, v188, v189
    s_nop 0
    s_nop 0
    v_mfma_f32_32x32x16_bf16 v[144:159], v[244:247], v[184:187], v[144:159]
    v_cvt_pk_bf16_f32 v81, v82, v83
    v_mfma_f32_16x16x32_bf16 v[252:255], v[20:23], v[184:187], v[252:255]
    s_waitcnt lgkmcnt(1)
    v_mfma_f32_32x32x16_bf16 v[176:191], v[48:51], v[112:115], 0
    s_setprio 0
    s_waitcnt lgkmcnt(0)
    v_mfma_f32_32x32x16_bf16 v[176:191], v[52:55], v[116:119], v[176:191]
    v_exp_f32 v201, v201
    v_cvt_pk_bf16_f32 v172, v172, v173
    v_mfma_f32_32x32x16_bf16 v[176:191], v[56:59], v[120:123], v[176:191]
    v_cvt_pk_bf16_f32 v88, v88, v89
    v_exp_f32 v198, v198
    v_exp_f32 v90, v90
    v_exp_f32 v92, v92
    v_exp_f32 v86, v86
    v_exp_f32 v206, v206
    v_exp_f32 v194, v194
    v_mfma_f32_32x32x16_bf16 v[176:191], v[60:63], v[124:127], v[176:191]
    v_exp_f32 v196, v196
    v_exp_f32 v195, v195
    v_exp_f32 v197, v197
    v_cvt_pk_bf16_f32 v192, v192, v193
    v_exp_f32 v207, v207
    s_nop 2
    v_cvt_pk_bf16_f32 v168, v176, v177
    v_exp_f32 v87, v87
    ds_write_b16_d16_hi v14, v172 offset:336
    v_cvt_pk_bf16_f32 v170, v180, v181
    v_cvt_pk_bf16_f32 v174, v188, v189
    v_cvt_pk_bf16_f32 v171, v182, v183
    v_cvt_pk_bf16_f32 v169, v178, v179
    v_cvt_pk_bf16_f32 v173, v186, v187
    ds_write_b16 v14, v172 offset:64
    v_exp_f32_e64 v205, v205
    v_mfma_f32_32x32x16_bf16 v[48:63], v[168:171], v[136:139], 0
    v_exp_f32_e64 v203, v203
    v_cvt_pk_bf16_f32 v175, v190, v191
    v_cvt_pk_bf16_f32 v172, v184, v185
    v_cvt_pk_bf16_f32 v193, v194, v195
    v_cvt_pk_bf16_f32 v89, v90, v91
    v_exp_f32 v202, v202
    v_mfma_f32_32x32x16_bf16 v[48:63], v[172:175], v[140:143], v[48:63]
    v_exp_f32 v200, v200
    v_exp_f32_e64 v84, v84
    v_mfma_f32_32x32x16_bf16 v[176:191], v[112:115], v[64:67], 0
    v_cvt_pk_bf16_f32 v200, v200, v201
    v_exp_f32_e64 v204, v204
    v_cvt_pk_bf16_f32 v82, v84, v85
    v_exp_f32_e64 v60, v60
    v_mfma_f32_16x16x32_bf16 v[64:67], v[232:235], v[168:171], 0
    v_exp_f32_e64 v48, v48
    v_mfma_f32_16x16x32_bf16 v[64:67], v[236:239], v[172:175], v[64:67]
    v_exp_f32 v49, v49
    s_setprio 2
    v_mfma_f32_32x32x16_bf16 v[176:191], v[116:119], v[68:71], v[176:191]
    v_exp_f32 v53, v53
    v_exp_f32 v94, v94
    v_exp_f32_e64 v64, v64
    v_cvt_pk_bf16_f32 v91, v94, v95
    v_mfma_f32_32x32x16_bf16 v[176:191], v[120:123], v[72:75], v[176:191]
    v_cvt_pk_bf16_f32 v83, v86, v87
    v_cvt_pk_bf16_f32 v195, v198, v199
    v_exp_f32 v50, v50
    v_exp_f32 v58, v58
    v_exp_f32_e64 v56, v56
    v_cvt_pk_bf16_f32 v90, v92, v93
    v_mfma_f32_32x32x16_bf16 v[176:191], v[124:127], v[76:79], v[176:191]
    v_exp_f32 v54, v54
    v_exp_f32 v51, v51
    v_cvt_pk_bf16_f32 v201, v202, v203
    ds_read_b64_tr_b16 v[86:87], v8 offset:25856
    v_exp_f32 v55, v55
    v_exp_f32 v59, v59
    v_exp_f32_e64 v65, v65
    v_cvt_pk_bf16_f32 v48, v48, v49
    v_cvt_pk_bf16_f32 v194, v196, v197
    v_cvt_pk_bf16_f32 v142, v188, v189
    v_cvt_pk_bf16_f32 v139, v182, v183
    v_mfma_f32_32x32x16_bf16 v[208:223], v[160:163], v[80:83], v[208:223]
    v_cvt_pk_bf16_f32 v136, v176, v177
    v_cvt_pk_bf16_f32 v143, v190, v191
    v_exp_f32_e64 v57, v57
    v_cvt_pk_bf16_f32 v49, v50, v51
    v_cvt_pk_bf16_f32 v138, v180, v181
    v_cvt_pk_bf16_f32 v137, v178, v179
    v_cvt_pk_bf16_f32 v141, v186, v187
    ds_read_b128 v[232:235], v2 offset:4096
    v_exp_f32_e64 v62, v62
    v_cvt_pk_bf16_f32 v51, v54, v55
    v_cvt_pk_bf16_f32 v64, v64, v65
    v_cvt_pk_bf16_f32 v140, v184, v185
    v_mfma_f32_32x32x16_bf16 v[176:191], v[168:171], v[40:43], 0
    ds_read_b64_tr_b16 v[84:85], v8 offset:25600
    v_mfma_f32_16x16x32_bf16 v[248:251], v[20:23], v[80:83], v[248:251]
    ds_read_b128 v[196:199], v2 offset:0
    v_mfma_f32_32x32x16_bf16 v[176:191], v[172:175], v[44:47], v[176:191]
    ds_read_b128 v[236:239], v4 offset:0
    ds_write_b16_d16_hi v14, v64 offset:400
    ds_read_b128 v[40:43], v3 offset:0
    ds_read_b64_tr_b16 v[92:93], v8 offset:27648
    ds_write_b16 v14, v64 offset:128
    ds_read_b64_tr_b16 v[82:83], v8 offset:24832
    ds_read_b64_tr_b16 v[80:81], v8 offset:24576
    s_setprio 1
    v_cvt_pk_bf16_f32 v56, v56, v57
    v_cvt_pk_bf16_f32 v203, v206, v207
    v_exp_f32 v63, v63
    v_exp_f32_e64 v52, v52
    v_cvt_pk_bf16_f32 v57, v58, v59
    v_mfma_f32_16x16x32_bf16 v[248:251], v[20:23], v[88:91], v[248:251]
    v_exp_f32_e64 v178, v178
    v_mfma_f32_32x32x16_bf16 v[208:223], v[164:167], v[88:91], v[208:223]
    v_exp_f32 v186, v186
    v_exp_f32 v188, v188
    v_cvt_pk_bf16_f32 v202, v204, v205
    v_exp_f32_e64 v185, v185
    v_exp_f32 v61, v61
    s_nop 0
    v_cvt_pk_bf16_f32 v58, v60, v61
    v_cvt_pk_bf16_f32 v50, v52, v53
    v_exp_f32_e64 v177, v177
    ds_read_b64_tr_b16 v[94:95], v8 offset:27904
    v_cvt_pk_bf16_f32 v59, v62, v63
    v_mfma_f32_32x32x16_bf16 v[208:223], v[136:139], v[48:51], v[208:223]
    ds_read_b128 v[52:55], v1 offset:0
    v_exp_f32 v176, v176
    v_exp_f32 v184, v184
    v_mfma_f32_32x32x16_bf16 v[208:223], v[140:143], v[56:59], v[208:223]
    v_exp_f32 v183, v183
    v_exp_f32 v182, v182
    ds_read_b64_tr_b16 v[90:91], v8 offset:26880
    v_cvt_pk_bf16_f32 v176, v176, v177
    v_mfma_f32_16x16x32_bf16 v[252:255], v[20:23], v[192:195], v[252:255]
    ds_read_b64_tr_b16 v[88:89], v8 offset:26624
    v_exp_f32_e64 v180, v180
    v_mfma_f32_16x16x32_bf16 v[248:251], v[20:23], v[48:51], v[248:251]
    v_exp_f32_e64 v187, v187
    v_mfma_f32_16x16x32_bf16 v[248:251], v[20:23], v[56:59], v[248:251]
    v_exp_f32 v179, v179
    v_exp_f32 v190, v190
    s_waitcnt lgkmcnt(2)
    v_mfma_f32_32x32x16_bf16 v[64:79], v[80:83], v[52:55], 0
    v_exp_f32 v181, v181
    v_exp_f32_e64 v189, v189
    v_cvt_pk_bf16_f32 v177, v178, v179
    v_cvt_pk_bf16_f32 v184, v184, v185
    v_mfma_f32_32x32x16_bf16 v[64:79], v[84:87], v[196:199], v[64:79]
    v_exp_f32 v191, v191
    v_rcp_f32_e64 v249, v248
    s_waitcnt lgkmcnt(0)
    v_mfma_f32_32x32x16_bf16 v[64:79], v[88:91], v[40:43], v[64:79]
    v_cvt_pk_bf16_f32 v179, v182, v183
    ds_read_b128 v[44:47], v4 offset:4096
    v_mfma_f32_32x32x16_bf16 v[64:79], v[92:95], v[236:239], v[64:79]
    ds_read_b128 v[48:51], v3 offset:4096
    ds_read_b128 v[60:63], v1 offset:4096
    v_cvt_pk_bf16_f32 v185, v186, v187
    v_mfma_f32_16x16x32_bf16 v[252:255], v[20:23], v[200:203], v[252:255]
    v_mfma_f32_32x32x16_bf16 v[144:159], v[160:163], v[192:195], v[144:159]
    s_setprio 3
    v_fmac_f32 v70, v214, v249
    v_fmac_f32 v65, v209, v249
    v_fmac_f32 v72, v216, v249
    v_fmac_f32 v68, v212, v249
    v_fmac_f32 v74, v218, v249
    v_fmac_f32 v76, v220, v249
    v_mfma_f32_32x32x16_bf16 v[144:159], v[164:167], v[200:203], v[144:159]
    v_fmac_f32 v64, v208, v249
    v_fmac_f32 v75, v219, v249
    v_fmac_f32 v66, v210, v249
    v_fmac_f32_e64 v69, v213, v249
    v_mfma_f32_32x32x16_bf16 v[192:207], v[96:99], v[112:115], 0
    v_fmac_f32 v77, v221, v249
    v_fmac_f32 v67, v211, v249
    v_fmac_f32_e64 v73, v217, v249
    v_cvt_pk_bf16_f32 v64, v64, v65
    v_fmac_f32 v71, v215, v249
    v_cvt_pk_bf16_f32 v65, v66, v67
    v_mfma_f32_32x32x16_bf16 v[192:207], v[100:103], v[116:119], v[192:207]
    s_setprio 2
    v_cvt_pk_bf16_f32 v67, v70, v71
    v_cvt_pk_bf16_f32 v178, v180, v181
    v_cvt_pk_bf16_f32 v66, v68, v69
    v_pk_max_i16 v64, v64, 0
    v_cvt_pk_bf16_f32 v68, v72, v73
    v_pk_max_i16 v67, v67, 0
    v_mfma_f32_32x32x16_bf16 v[192:207], v[104:107], v[120:123], v[192:207]
    v_cvt_pk_bf16_f32 v186, v188, v189
    v_pk_max_i16 v65, v65, 0
    v_pk_max_i16 v66, v66, 0
    v_fmac_f32_e64 v78, v222, v249
    v_pk_max_i16 v68, v68, 0
    v_cvt_pk_bf16_f32 v69, v74, v75
    v_mfma_f32_32x32x16_bf16 v[192:207], v[108:111], v[124:127], v[192:207]
    ds_write_b128 v9, v[64:67]
    v_mfma_f32_16x16x32_bf16 v[252:255], v[20:23], v[176:179], v[252:255]
    v_cvt_pk_bf16_f32 v187, v190, v191
    v_fmac_f32 v79, v223, v249
    v_mfma_f32_32x32x16_bf16 v[144:159], v[136:139], v[176:179], v[144:159]
    v_cvt_pk_bf16_f32 v71, v78, v79
    v_pk_max_i16 v69, v69, 0
    v_pk_max_i16 v71, v71, 0
    v_cvt_pk_bf16_f32 v70, v76, v77
    v_pk_max_i16 v70, v70, 0
    v_cvt_pk_bf16_f32 v53, v194, v195
    v_mfma_f32_32x32x16_bf16 v[144:159], v[140:143], v[184:187], v[144:159]
    ds_write_b128 v10, v[68:71]
    s_waitcnt lgkmcnt(2)
    v_mfma_f32_32x32x16_bf16 v[112:127], v[80:83], v[60:63], 0
    v_cvt_pk_bf16_f32 v55, v198, v199
    ds_read_b128 v[72:75], v11 offset:0
    v_cvt_pk_bf16_f32 v52, v192, v193
    v_mfma_f32_32x32x16_bf16 v[112:127], v[84:87], v[232:235], v[112:127]
    v_cvt_pk_bf16_f32 v54, v196, v197
    v_cvt_pk_bf16_f32 v236, v200, v201
    v_cvt_pk_bf16_f32 v239, v206, v207
    v_mfma_f32_16x16x32_bf16 v[252:255], v[20:23], v[184:187], v[252:255]
    v_mfma_f32_32x32x16_bf16 v[112:127], v[88:91], v[48:51], v[112:127]
    v_cvt_pk_bf16_f32 v238, v204, v205
    s_setprio 3
    v_mfma_f32_32x32x16_bf16 v[112:127], v[92:95], v[44:47], v[112:127]
    s_waitcnt lgkmcnt(0)
    buffer_store_dwordx4 v[72:75], v12, s[24:27], 0 offen offset:0 sc0 sc1 nt
    ds_read_b128 v[76:79], v11 offset:1024
    v_mfma_f32_32x32x16_bf16 v[176:191], v[30:33], v[52:55], 0
    v_rcp_f32 v253, v252
    v_cvt_pk_bf16_f32 v237, v202, v203
    v_fmac_f32 v125, v157, v253
    v_fmac_f32 v120, v152, v253
    v_fmac_f32 v116, v148, v253
    v_mfma_f32_16x16x32_bf16 v[208:211], v[224:227], v[52:55], 0
    v_fmac_f32 v123, v155, v253
    v_fmac_f32 v112, v144, v253
    v_mfma_f32_32x32x16_bf16 v[176:191], v[36:39], v[236:239], v[176:191]
    v_fmac_f32 v127, v159, v253
    v_fmac_f32 v121, v153, v253
    v_fmac_f32 v115, v147, v253
    v_fmac_f32 v119, v151, v253
    v_fmac_f32 v117, v149, v253
    v_mfma_f32_16x16x32_bf16 v[208:211], v[228:231], v[236:239], v[208:211]
    v_fmac_f32 v114, v146, v253
    v_fmac_f32 v124, v156, v253
    v_mfma_f32_32x32x16_bf16 v[96:111], v[128:131], v[52:55], 0
    v_exp_f32 v188, v188
    v_fmac_f32 v113, v145, v253
    v_cvt_pk_bf16_f32 v112, v112, v113
    v_fmac_f32 v122, v154, v253
    v_fmac_f32_e64 v118, v150, v253
    v_mfma_f32_32x32x16_bf16 v[96:111], v[132:135], v[236:239], v[96:111]
    v_cvt_pk_bf16_f32 v113, v114, v115
    v_cvt_pk_bf16_f32 v115, v118, v119
    v_pk_max_i16 v112, v112, 0
    v_fmac_f32_e64 v126, v158, v253
    v_cvt_pk_bf16_f32 v114, v116, v117
    v_cvt_pk_bf16_f32 v117, v122, v123
    ds_read_b128 v[44:47], v16 offset:0
    v_mfma_f32_32x32x16_bf16 v[144:159], v[168:171], v[52:55], 0
    v_cvt_pk_bf16_f32 v118, v124, v125
    v_cvt_pk_bf16_f32 v116, v120, v121
    v_pk_max_i16 v114, v114, 0
    v_pk_max_i16 v116, v116, 0
    v_pk_max_i16 v113, v113, 0
    v_pk_max_i16 v118, v118, 0
    ds_read_b128 v[212:215], v16 offset:160
    v_pk_max_i16 v117, v117, 0
    s_waitcnt lgkmcnt(2)
    buffer_store_dwordx4 v[76:79], v12, s[24:27], 0 offen offset:2048 sc0 sc1 nt
    ds_read_b128 v[192:195], v1 offset:8192
    v_pk_max_i16 v115, v115, 0
    ds_write_b128 v9, v[112:115]
    v_mfma_f32_32x32x16_bf16 v[144:159], v[172:175], v[236:239], v[144:159]
    v_exp_f32 v108, v108
    v_cvt_pk_bf16_f32 v119, v126, v127
    v_pk_max_i16 v119, v119, 0
    v_exp_f32_e64 v209, v209
    ds_write_b128 v10, v[116:119]
    ds_read_b128 v[124:127], v11 offset:1024
    v_exp_f32_e64 v100, v100
    ds_read_b128 v[220:223], v4 offset:8192
    v_exp_f32_e64 v99, v99
    ds_read_b128 v[216:219], v2 offset:8192
    ds_read_b128 v[120:123], v11 offset:0
    ds_read_b128 v[48:51], v16 offset:32
    ds_read_b128 v[196:199], v3 offset:8192
    v_exp_f32 v208, v208
    ds_read_b128 v[40:43], v16 offset:64
    v_exp_f32 v98, v98
    v_exp_f32 v107, v107
    s_waitcnt lgkmcnt(6)
    buffer_store_dwordx4 v[124:127], v12, s[24:27], s39 offen offset:2048 sc0 sc1 nt
    s_setprio 0
    s_waitcnt lgkmcnt(3)
    buffer_store_dwordx4 v[120:123], v12, s[24:27], s39 offen offset:0 sc0 sc1 nt
    ds_read_b64 v[254:255], v16 offset:192
    v_exp_f32 v176, v176
    v_exp_f32 v96, v96
    v_exp_f32 v183, v183
    v_exp_f32 v103, v103
    v_exp_f32 v190, v190
    v_exp_f32 v152, v152
    v_exp_f32 v179, v179
    v_exp_f32 v180, v180
    v_exp_f32 v101, v101
    v_exp_f32 v104, v104
    v_exp_f32 v178, v178
    v_exp_f32 v97, v97
    v_exp_f32 v102, v102
    v_exp_f32 v177, v177
    v_exp_f32 v187, v187
    v_exp_f32_e64 v110, v110
    s_waitcnt lgkmcnt(0)
    v_mfma_f32_16x16x16_bf16 v[232:235], v[254:255], v[24:25], 0
    v_cvt_pk_bf16_f32 v96, v96, v97
    v_mov_b32 v37, 0x3f803f80
    v_mfma_f32_32x32x16_bf16 v[120:135], v[80:83], v[192:195], 0
    v_cvt_pk_bf16_f32 v97, v98, v99
    v_cvt_pk_bf16_f32 v176, v176, v177
    v_cvt_pk_bf16_f32 v177, v178, v179
    v_cvt_pk_bf16_f32 v18, v208, v209
    v_exp_f32 v182, v182
    s_nop 0
    v_mfma_f32_32x32x8_bf16 v[60:75], v[24:25], v[18:19], 0
    v_exp_f32 v109, v109
    v_mov_b32 v39, 0x3f803f80
    v_exp_f32 v145, v145
    v_cvt_pk_bf16_f32 v99, v102, v103
    v_mfma_f32_16x16x32_bf16 v[232:235], v[44:47], v[240:243], v[232:235]
    v_exp_f32 v181, v181
    v_mfma_f32_32x32x16_bf16 v[120:135], v[84:87], v[216:219], v[120:135]
    v_exp_f32 v105, v105
    v_exp_f32 v184, v184
    v_exp_f32 v111, v111
    v_exp_f32_e64 v146, v146
    v_cvt_pk_bf16_f32 v98, v100, v101
    v_mfma_f32_32x32x16_bf16 v[120:135], v[88:91], v[196:199], v[120:135]
    v_cvt_pk_bf16_f32 v178, v180, v181
    v_exp_f32 v148, v148
    v_exp_f32 v106, v106
    v_exp_f32_e64 v189, v189
    v_mfma_f32_32x32x16_bf16 v[60:75], v[240:243], v[96:99], v[60:75]
    v_cvt_pk_bf16_f32 v104, v104, v105
    v_cvt_pk_bf16_f32 v179, v182, v183
    v_exp_f32 v144, v144
    v_cvt_pk_bf16_f32 v105, v106, v107
    v_exp_f32 v149, v149
    v_mfma_f32_16x16x16_bf16 v[76:79], v[20:21], v[18:19], 0
    v_exp_f32_e64 v191, v191
    v_mfma_f32_32x32x16_bf16 v[120:135], v[92:95], v[220:223], v[120:135]
    v_exp_f32_e64 v155, v155
    v_cvt_pk_bf16_f32 v106, v108, v109
    v_cvt_pk_bf16_f32 v107, v110, v111
    v_exp_f32 v185, v185
    v_mfma_f32_16x16x32_bf16 v[76:79], v[20:23], v[96:99], v[76:79]
    v_exp_f32 v186, v186
    v_mfma_f32_32x32x16_bf16 v[60:75], v[244:247], v[104:107], v[60:75]
    v_exp_f32 v150, v150
    s_setprio 3
    v_exp_f32 v154, v154
    v_exp_f32 v147, v147
    v_mfma_f32_16x16x32_bf16 v[76:79], v[20:23], v[104:107], v[76:79]
    v_cvt_pk_bf16_f32 v184, v184, v185
    v_cvt_pk_bf16_f32 v185, v186, v187
    v_mfma_f32_16x16x32_bf16 v[76:79], v[20:23], v[176:179], v[76:79]
    v_exp_f32_e64 v158, v158
    v_mfma_f32_32x32x16_bf16 v[60:75], v[160:163], v[176:179], v[60:75]
    v_cvt_pk_bf16_f32 v186, v188, v189
    v_cvt_pk_bf16_f32 v187, v190, v191
    v_exp_f32 v151, v151
    v_exp_f32 v153, v153
    v_mfma_f32_32x32x16_bf16 v[60:75], v[164:167], v[184:187], v[60:75]
    v_cvt_pk_bf16_f32 v144, v144, v145
    v_exp_f32_e64 v159, v159
    v_cvt_pk_bf16_f32 v152, v152, v153
    v_cvt_pk_bf16_f32 v145, v146, v147
    v_cvt_pk_bf16_f32 v146, v148, v149
    v_mfma_f32_16x16x32_bf16 v[76:79], v[20:23], v[184:187], v[76:79]
    v_cvt_pk_bf16_f32 v147, v150, v151
    v_cvt_pk_bf16_f32 v153, v154, v155
    v_mov_b32 v250, 0x3f803f80
    v_mfma_f32_32x32x16_bf16 v[60:75], v[136:139], v[144:147], v[60:75]
    v_exp_f32 v157, v157
    v_exp_f32 v156, v156
    v_cvt_pk_bf16_f32 v155, v158, v159
    v_cvt_pk_bf16_f32 v154, v156, v157
    v_mfma_f32_16x16x32_bf16 v[76:79], v[20:23], v[144:147], v[76:79]
    ds_read_b128 v[32:35], v16 offset:128
    v_mfma_f32_16x16x32_bf16 v[76:79], v[20:23], v[152:155], v[76:79]
    ds_read_b64 v[202:203], v7 offset:4096
    v_mfma_f32_32x32x16_bf16 v[60:75], v[140:143], v[152:155], v[60:75]
    ds_read_b128 v[56:59], v16 offset:96
    v_mov_b32_e64 v251, 0
    v_mov_b32 v36, 0x3f803f80
    v_mov_b32 v38, 0x3f803f80
    v_max3_u32 v17, v248, v249, v17
    v_mfma_f32_16x16x16_bf16 v[204:207], v[254:255], v[250:251], 0
    v_rcp_f32_e64 v77, v76
    v_mfma_f32_16x16x32_bf16 v[232:235], v[48:51], v[244:247], v[232:235]
    v_fmac_f32 v128, v68, v77
    v_fmac_f32 v123, v63, v77
    v_mfma_f32_16x16x32_bf16 v[232:235], v[40:43], v[160:163], v[232:235]
    v_fmac_f32 v127, v67, v77
    v_fmac_f32 v124, v64, v77
    v_fmac_f32 v121, v61, v77
    v_mfma_f32_16x16x32_bf16 v[204:207], v[44:47], v[36:39], v[204:207]
    v_fmac_f32 v122, v62, v77
    v_fmac_f32 v130, v70, v77
    v_fmac_f32 v120, v60, v77
    v_fmac_f32 v132, v72, v77
    v_fmac_f32 v133, v73, v77
    v_fmac_f32 v126, v66, v77
    v_fmac_f32 v129, v69, v77
    v_fmac_f32_e64 v125, v65, v77
    v_cvt_pk_bf16_f32 v120, v120, v121
    v_cvt_pk_bf16_f32 v121, v122, v123
    v_fmac_f32_e64 v135, v75, v77
    v_mfma_f32_16x16x32_bf16 v[204:207], v[48:51], v[36:39], v[204:207]
    v_pk_max_i16 v120, v120, 0
    v_cvt_pk_bf16_f32 v123, v126, v127
    v_fmac_f32_e64 v134, v74, v77
    v_cvt_pk_bf16_f32 v122, v124, v125
    v_cvt_pk_bf16_f32 v127, v134, v135
    v_fmac_f32 v131, v71, v77
    v_mfma_f32_16x16x32_bf16 v[204:207], v[40:43], v[36:39], v[204:207]
    v_cvt_pk_bf16_f32 v124, v128, v129
    v_pk_max_i16 v123, v123, 0
    v_cvt_pk_bf16_f32 v126, v132, v133
    v_pk_max_i16 v121, v121, 0
    s_waitcnt lgkmcnt(0)
    v_mfma_f32_16x16x32_bf16 v[204:207], v[56:59], v[36:39], v[204:207]
    v_pk_max_i16 v122, v122, 0
    v_pk_max_i16 v124, v124, 0
    v_mfma_f32_16x16x32_bf16 v[204:207], v[32:35], v[36:39], v[204:207]
    ds_write_b128 v9, v[120:123]
    v_mfma_f32_16x16x32_bf16 v[204:207], v[212:215], v[36:39], v[204:207]
    v_cvt_pk_bf16_f32 v125, v130, v131
    v_pk_max_i16 v127, v127, 0
    v_pk_max_i16 v125, v125, 0
    v_pk_max_i16 v126, v126, 0
    v_mfma_f32_16x16x32_bf16 v[232:235], v[56:59], v[164:167], v[232:235]
    ds_write_b128 v10, v[124:127]
    v_mfma_f32_16x16x32_bf16 v[232:235], v[32:35], v[136:139], v[232:235]
    ds_read_b128 v[128:131], v11 offset:0
    v_mfma_f32_16x16x32_bf16 v[232:235], v[212:215], v[140:143], v[232:235]
    v_max3_u32 v17, v252, v253, v17
    ds_read_b128 v[132:135], v11 offset:1024
    v_rcp_f32 v207, v205
    v_rcp_f32_e64 v206, v204
    s_nop 0
    v_max3_u32 v17, v204, v206, v17
    v_fma_f32 v232, v232, v206, v202
    v_fma_f32 v233, v233, v207, v203
    v_cvt_pk_bf16_f32 v232, v232, v233
    v_pk_max_i16 v232, v232, 0
    buffer_store_short_d16_hi v232, v13, s[24:27], 0 offen offset:128 sc0 sc1 nt
    v_max3_u32 v17, v205, v207, v17
    buffer_store_short v232, v13, s[24:27], 0 offen sc0 sc1 nt
    s_waitcnt lgkmcnt(1)
    buffer_store_dwordx4 v[128:131], v12, s[24:27], s40 offen offset:0 sc0 sc1 nt
    s_waitcnt lgkmcnt(0)
    buffer_store_dwordx4 v[132:135], v12, s[24:27], s40 offen offset:2048 sc0 sc1 nt
    v_max3_u32 v17, v76, v77, v17
L_hiend:
L_fin:
    s_mov_b32 s46, 0x53800000
    s_nop 4
    v_cmp_le_u32 vcc, s46, v17
    s_nop 4
    s_cbranch_vccnz L_safe
L_end:
    s_endpgm
L_safe:
    s_waitcnt vmcnt(0) lgkmcnt(0)
    s_nop 15
    s_nop 15
    ds_read_b64_tr_b16 v[32:33], v26 offset:8192
    ds_read_b64_tr_b16 v[34:35], v26 offset:8448
    ds_read_b64_tr_b16 v[36:37], v26 offset:9216
    ds_read_b64_tr_b16 v[38:39], v26 offset:9472
    ds_read_b64_tr_b16 v[40:41], v26 offset:10240
    ds_read_b64_tr_b16 v[42:43], v26 offset:10496
    ds_read_b64_tr_b16 v[44:45], v26 offset:11264
    ds_read_b64_tr_b16 v[46:47], v26 offset:11520
    ds_read_b64_tr_b16 v[48:49], v8 offset:16384
    ds_read_b64_tr_b16 v[50:51], v8 offset:16640
    ds_read_b64_tr_b16 v[52:53], v8 offset:17408
    ds_read_b64_tr_b16 v[54:55], v8 offset:17664
    ds_read_b64_tr_b16 v[56:57], v8 offset:18432
    ds_read_b64_tr_b16 v[58:59], v8 offset:18688
    ds_read_b64_tr_b16 v[60:61], v8 offset:19456
    ds_read_b64_tr_b16 v[62:63], v8 offset:19712
    ds_read_b128 v[64:67], v1 offset:0
    ds_read_b128 v[68:71], v2 offset:0
    ds_read_b128 v[72:75], v3 offset:0
    ds_read_b128 v[76:79], v4 offset:0
    s_waitcnt lgkmcnt(3)
    v_mfma_f32_32x32x16_bf16 v[80:95], v[32:35], v[64:67], 0
    s_waitcnt lgkmcnt(2)
    v_mfma_f32_32x32x16_bf16 v[80:95], v[36:39], v[68:71], v[80:95]
    s_waitcnt lgkmcnt(1)
    v_mfma_f32_32x32x16_bf16 v[80:95], v[40:43], v[72:75], v[80:95]
    s_waitcnt lgkmcnt(0)
    v_mfma_f32_32x32x16_bf16 v[80:95], v[44:47], v[76:79], v[80:95]
    s_nop 11
    v_cvt_pk_bf16_f32 v96, v80, v81
    v_cvt_pk_bf16_f32 v97, v82, v83
    v_cvt_pk_bf16_f32 v98, v84, v85
    v_cvt_pk_bf16_f32 v99, v86, v87
    v_cvt_pk_bf16_f32 v100, v88, v89
    v_cvt_pk_bf16_f32 v101, v90, v91
    v_cvt_pk_bf16_f32 v102, v92, v93
    v_cvt_pk_bf16_f32 v103, v94, v95
    v_mfma_f32_32x32x16_bf16 v[112:127], v[64:67], v[48:51], 0
    v_mfma_f32_32x32x16_bf16 v[112:127], v[68:71], v[52:55], v[112:127]
    v_mfma_f32_32x32x16_bf16 v[112:127], v[72:75], v[56:59], v[112:127]
    v_mfma_f32_32x32x16_bf16 v[112:127], v[76:79], v[60:63], v[112:127]
    s_nop 11
    v_cvt_pk_bf16_f32 v104, v112, v113
    v_cvt_pk_bf16_f32 v105, v114, v115
    v_cvt_pk_bf16_f32 v106, v116, v117
    v_cvt_pk_bf16_f32 v107, v118, v119
    v_cvt_pk_bf16_f32 v108, v120, v121
    v_cvt_pk_bf16_f32 v109, v122, v123
    v_cvt_pk_bf16_f32 v110, v124, v125
    v_cvt_pk_bf16_f32 v111, v126, v127
    ds_read_b128 v[128:131], v1 offset:4096
    ds_read_b128 v[132:135], v2 offset:4096
    ds_read_b128 v[136:139], v3 offset:4096
    ds_read_b128 v[140:143], v4 offset:4096
    s_waitcnt lgkmcnt(3)
    v_mfma_f32_32x32x16_bf16 v[144:159], v[32:35], v[128:131], 0
    s_waitcnt lgkmcnt(2)
    v_mfma_f32_32x32x16_bf16 v[144:159], v[36:39], v[132:135], v[144:159]
    s_waitcnt lgkmcnt(1)
    v_mfma_f32_32x32x16_bf16 v[144:159], v[40:43], v[136:139], v[144:159]
    s_waitcnt lgkmcnt(0)
    v_mfma_f32_32x32x16_bf16 v[144:159], v[44:47], v[140:143], v[144:159]
    s_nop 11
    v_cvt_pk_bf16_f32 v160, v144, v145
    v_cvt_pk_bf16_f32 v161, v146, v147
    v_cvt_pk_bf16_f32 v162, v148, v149
    v_cvt_pk_bf16_f32 v163, v150, v151
    v_cvt_pk_bf16_f32 v164, v152, v153
    v_cvt_pk_bf16_f32 v165, v154, v155
    v_cvt_pk_bf16_f32 v166, v156, v157
    v_cvt_pk_bf16_f32 v167, v158, v159
    v_mfma_f32_32x32x16_bf16 v[176:191], v[128:131], v[48:51], 0
    v_mfma_f32_32x32x16_bf16 v[176:191], v[132:135], v[52:55], v[176:191]
    v_mfma_f32_32x32x16_bf16 v[176:191], v[136:139], v[56:59], v[176:191]
    v_mfma_f32_32x32x16_bf16 v[176:191], v[140:143], v[60:63], v[176:191]
    s_nop 11
    v_cvt_pk_bf16_f32 v168, v176, v177
    v_cvt_pk_bf16_f32 v169, v178, v179
    v_cvt_pk_bf16_f32 v170, v180, v181
    v_cvt_pk_bf16_f32 v171, v182, v183
    v_cvt_pk_bf16_f32 v172, v184, v185
    v_cvt_pk_bf16_f32 v173, v186, v187
    v_cvt_pk_bf16_f32 v174, v188, v189
    v_cvt_pk_bf16_f32 v175, v190, v191
    ds_read_b128 v[192:195], v1 offset:8192
    ds_read_b128 v[196:199], v2 offset:8192
    ds_read_b128 v[200:203], v3 offset:8192
    ds_read_b128 v[204:207], v4 offset:8192
    s_waitcnt lgkmcnt(3)
    v_mfma_f32_32x32x16_bf16 v[208:223], v[32:35], v[192:195], 0
    s_waitcnt lgkmcnt(2)
    v_mfma_f32_32x32x16_bf16 v[208:223], v[36:39], v[196:199], v[208:223]
    s_waitcnt lgkmcnt(1)
    v_mfma_f32_32x32x16_bf16 v[208:223], v[40:43], v[200:203], v[208:223]
    s_waitcnt lgkmcnt(0)
    v_mfma_f32_32x32x16_bf16 v[208:223], v[44:47], v[204:207], v[208:223]
    s_nop 11
    v_cvt_pk_bf16_f32 v224, v208, v209
    v_cvt_pk_bf16_f32 v225, v210, v211
    v_cvt_pk_bf16_f32 v226, v212, v213
    v_cvt_pk_bf16_f32 v227, v214, v215
    v_cvt_pk_bf16_f32 v228, v216, v217
    v_cvt_pk_bf16_f32 v229, v218, v219
    v_cvt_pk_bf16_f32 v230, v220, v221
    v_cvt_pk_bf16_f32 v231, v222, v223
    v_mfma_f32_32x32x16_bf16 v[240:255], v[192:195], v[48:51], 0
    v_mfma_f32_32x32x16_bf16 v[240:255], v[196:199], v[52:55], v[240:255]
    v_mfma_f32_32x32x16_bf16 v[240:255], v[200:203], v[56:59], v[240:255]
    v_mfma_f32_32x32x16_bf16 v[240:255], v[204:207], v[60:63], v[240:255]
    s_nop 11
    v_cvt_pk_bf16_f32 v232, v240, v241
    v_cvt_pk_bf16_f32 v233, v242, v243
    v_cvt_pk_bf16_f32 v234, v244, v245
    v_cvt_pk_bf16_f32 v235, v246, v247
    v_cvt_pk_bf16_f32 v236, v248, v249
    v_cvt_pk_bf16_f32 v237, v250, v251
    v_cvt_pk_bf16_f32 v238, v252, v253
    v_cvt_pk_bf16_f32 v239, v254, v255
    ds_read_b128 v[80:83], v5 offset:0
    ds_read_b128 v[84:87], v5 offset:256
    ds_read_b64 v[30:31], v7
    s_waitcnt lgkmcnt(0)
    v_cvt_pk_bf16_f32 v24, v30, v31
    ds_read_b64_tr_b16 v[64:65], v28 offset:0
    ds_read_b64_tr_b16 v[66:67], v28 offset:256
    ds_read_b64_tr_b16 v[68:69], v28 offset:1024
    ds_read_b64_tr_b16 v[70:71], v28 offset:1280
    ds_read_b64_tr_b16 v[72:73], v28 offset:2048
    ds_read_b64_tr_b16 v[74:75], v28 offset:2304
    ds_read_b64_tr_b16 v[76:77], v28 offset:3072
    ds_read_b64_tr_b16 v[78:79], v28 offset:3328
    ds_read_b64_tr_b16 v[112:113], v8 offset:24576
    ds_read_b64_tr_b16 v[114:115], v8 offset:24832
    ds_read_b64_tr_b16 v[116:117], v8 offset:25600
    ds_read_b64_tr_b16 v[118:119], v8 offset:25856
    ds_read_b64_tr_b16 v[120:121], v8 offset:26624
    ds_read_b64_tr_b16 v[122:123], v8 offset:26880
    ds_read_b64_tr_b16 v[124:125], v8 offset:27648
    ds_read_b64_tr_b16 v[126:127], v8 offset:27904
    ds_read_b128 v[144:147], v1 offset:0
    ds_read_b128 v[148:151], v2 offset:0
    ds_read_b128 v[152:155], v3 offset:0
    ds_read_b128 v[156:159], v4 offset:0
    s_waitcnt lgkmcnt(3)
    v_mfma_f32_32x32x16_bf16 v[128:143], v[64:67], v[144:147], 0
    s_waitcnt lgkmcnt(2)
    v_mfma_f32_32x32x16_bf16 v[128:143], v[68:71], v[148:151], v[128:143]
    s_waitcnt lgkmcnt(1)
    v_mfma_f32_32x32x16_bf16 v[128:143], v[72:75], v[152:155], v[128:143]
    s_waitcnt lgkmcnt(0)
    v_mfma_f32_32x32x16_bf16 v[128:143], v[76:79], v[156:159], v[128:143]
    s_nop 11
    v_cvt_pk_bf16_f32 v88, v128, v129
    v_cvt_pk_bf16_f32 v89, v130, v131
    v_cvt_pk_bf16_f32 v90, v132, v133
    v_cvt_pk_bf16_f32 v91, v134, v135
    v_cvt_pk_bf16_f32 v92, v136, v137
    v_cvt_pk_bf16_f32 v93, v138, v139
    v_cvt_pk_bf16_f32 v94, v140, v141
    v_cvt_pk_bf16_f32 v95, v142, v143
    v_mfma_f32_32x32x16_bf16 v[176:191], v[112:115], v[144:147], 0
    v_mfma_f32_32x32x16_bf16 v[176:191], v[116:119], v[148:151], v[176:191]
    v_mfma_f32_32x32x16_bf16 v[176:191], v[120:123], v[152:155], v[176:191]
    v_mfma_f32_32x32x16_bf16 v[176:191], v[124:127], v[156:159], v[176:191]
    v_mfma_f32_32x32x16_bf16 v[32:47], v[96:99], v[88:91], 0
    v_mfma_f32_32x32x16_bf16 v[32:47], v[100:103], v[92:95], v[32:47]
    v_mfma_f32_32x32x16_bf16 v[208:223], v[160:163], v[88:91], 0
    v_mfma_f32_32x32x16_bf16 v[208:223], v[164:167], v[92:95], v[208:223]
    v_mfma_f32_32x32x16_bf16 v[48:63], v[224:227], v[88:91], 0
    v_mfma_f32_32x32x16_bf16 v[48:63], v[228:231], v[92:95], v[48:63]
    v_mfma_f32_16x16x32_bf16 v[192:195], v[80:83], v[88:91], 0
    v_mfma_f32_16x16x32_bf16 v[192:195], v[84:87], v[92:95], v[192:195]
    v_max_f32 v196, v32, v33
    v_max3_f32 v196, v34, v35, v196
    v_max3_f32 v196, v36, v37, v196
    v_max3_f32 v196, v38, v39, v196
    v_max3_f32 v196, v40, v41, v196
    v_max3_f32 v196, v42, v43, v196
    v_max3_f32 v196, v44, v45, v196
    v_max3_f32 v196, v46, v47, v196
    v_max3_f32 v196, v208, v209, v196
    v_max3_f32 v196, v210, v211, v196
    v_max3_f32 v196, v212, v213, v196
    v_max3_f32 v196, v214, v215, v196
    v_max3_f32 v196, v216, v217, v196
    v_max3_f32 v196, v218, v219, v196
    v_max3_f32 v196, v220, v221, v196
    v_max3_f32 v196, v222, v223, v196
    v_max3_f32 v196, v48, v49, v196
    v_max3_f32 v196, v50, v51, v196
    v_max3_f32 v196, v52, v53, v196
    v_max3_f32 v196, v54, v55, v196
    v_max3_f32 v196, v56, v57, v196
    v_max3_f32 v196, v58, v59, v196
    v_max3_f32 v196, v60, v61, v196
    v_max3_f32 v196, v62, v63, v196
    v_max3_f32 v196, v192, v193, v196
    v_mov_b32 v197, v196
    s_nop 1
    v_permlane32_swap_b32 v196, v197
    v_max_f32 v196, v196, v197
    v_sub_f32 v32, v32, v196
    v_sub_f32 v33, v33, v196
    v_sub_f32 v34, v34, v196
    v_sub_f32 v35, v35, v196
    v_sub_f32 v36, v36, v196
    v_sub_f32 v37, v37, v196
    v_sub_f32 v38, v38, v196
    v_sub_f32 v39, v39, v196
    v_sub_f32 v40, v40, v196
    v_sub_f32 v41, v41, v196
    v_sub_f32 v42, v42, v196
    v_sub_f32 v43, v43, v196
    v_sub_f32 v44, v44, v196
    v_sub_f32 v45, v45, v196
    v_sub_f32 v46, v46, v196
    v_sub_f32 v47, v47, v196
    v_sub_f32 v208, v208, v196
    v_sub_f32 v209, v209, v196
    v_sub_f32 v210, v210, v196
    v_sub_f32 v211, v211, v196
    v_sub_f32 v212, v212, v196
    v_sub_f32 v213, v213, v196
    v_sub_f32 v214, v214, v196
    v_sub_f32 v215, v215, v196
    v_sub_f32 v216, v216, v196
    v_sub_f32 v217, v217, v196
    v_sub_f32 v218, v218, v196
    v_sub_f32 v219, v219, v196
    v_sub_f32 v220, v220, v196
    v_sub_f32 v221, v221, v196
    v_sub_f32 v222, v222, v196
    v_sub_f32 v223, v223, v196
    v_sub_f32 v48, v48, v196
    v_sub_f32 v49, v49, v196
    v_sub_f32 v50, v50, v196
    v_sub_f32 v51, v51, v196
    v_sub_f32 v52, v52, v196
    v_sub_f32 v53, v53, v196
    v_sub_f32 v54, v54, v196
    v_sub_f32 v55, v55, v196
    v_sub_f32 v56, v56, v196
    v_sub_f32 v57, v57, v196
    v_sub_f32 v58, v58, v196
    v_sub_f32 v59, v59, v196
    v_sub_f32 v60, v60, v196
    v_sub_f32 v61, v61, v196
    v_sub_f32 v62, v62, v196
    v_sub_f32 v63, v63, v196
    v_sub_f32 v192, v192, v196
    v_sub_f32 v193, v193, v196
    v_exp_f32 v192, v192
    v_exp_f32 v193, v193
    s_nop 0
    v_cvt_pk_bf16_f32 v18, v192, v193
    s_nop 1
    v_mfma_f32_32x32x8_bf16 v[240:255], v[24:25], v[18:19], 0
    v_mfma_f32_16x16x16_bf16 v[88:91], v[20:21], v[18:19], 0
    v_exp_f32 v32, v32
    v_exp_f32 v33, v33
    v_exp_f32 v34, v34
    v_exp_f32 v35, v35
    v_exp_f32 v36, v36
    v_exp_f32 v37, v37
    v_exp_f32 v38, v38
    v_exp_f32 v39, v39
    v_cvt_pk_bf16_f32 v32, v32, v33
    v_cvt_pk_bf16_f32 v33, v34, v35
    v_cvt_pk_bf16_f32 v34, v36, v37
    v_cvt_pk_bf16_f32 v35, v38, v39
    s_nop 1
    v_mfma_f32_16x16x32_bf16 v[88:91], v[20:23], v[32:35], v[88:91]
    v_mfma_f32_32x32x16_bf16 v[240:255], v[104:107], v[32:35], v[240:255]
    v_exp_f32 v40, v40
    v_exp_f32 v41, v41
    v_exp_f32 v42, v42
    v_exp_f32 v43, v43
    v_exp_f32 v44, v44
    v_exp_f32 v45, v45
    v_exp_f32 v46, v46
    v_exp_f32 v47, v47
    v_cvt_pk_bf16_f32 v40, v40, v41
    v_cvt_pk_bf16_f32 v41, v42, v43
    v_cvt_pk_bf16_f32 v42, v44, v45
    v_cvt_pk_bf16_f32 v43, v46, v47
    s_nop 1
    v_mfma_f32_16x16x32_bf16 v[88:91], v[20:23], v[40:43], v[88:91]
    v_mfma_f32_32x32x16_bf16 v[240:255], v[108:111], v[40:43], v[240:255]
    v_exp_f32 v208, v208
    v_exp_f32 v209, v209
    v_exp_f32 v210, v210
    v_exp_f32 v211, v211
    v_exp_f32 v212, v212
    v_exp_f32 v213, v213
    v_exp_f32 v214, v214
    v_exp_f32 v215, v215
    v_cvt_pk_bf16_f32 v208, v208, v209
    v_cvt_pk_bf16_f32 v209, v210, v211
    v_cvt_pk_bf16_f32 v210, v212, v213
    v_cvt_pk_bf16_f32 v211, v214, v215
    s_nop 1
    v_mfma_f32_16x16x32_bf16 v[88:91], v[20:23], v[208:211], v[88:91]
    v_mfma_f32_32x32x16_bf16 v[240:255], v[168:171], v[208:211], v[240:255]
    v_exp_f32 v216, v216
    v_exp_f32 v217, v217
    v_exp_f32 v218, v218
    v_exp_f32 v219, v219
    v_exp_f32 v220, v220
    v_exp_f32 v221, v221
    v_exp_f32 v222, v222
    v_exp_f32 v223, v223
    v_cvt_pk_bf16_f32 v216, v216, v217
    v_cvt_pk_bf16_f32 v217, v218, v219
    v_cvt_pk_bf16_f32 v218, v220, v221
    v_cvt_pk_bf16_f32 v219, v222, v223
    s_nop 1
    v_mfma_f32_16x16x32_bf16 v[88:91], v[20:23], v[216:219], v[88:91]
    v_mfma_f32_32x32x16_bf16 v[240:255], v[172:175], v[216:219], v[240:255]
    v_exp_f32 v48, v48
    v_exp_f32 v49, v49
    v_exp_f32 v50, v50
    v_exp_f32 v51, v51
    v_exp_f32 v52, v52
    v_exp_f32 v53, v53
    v_exp_f32 v54, v54
    v_exp_f32 v55, v55
    v_cvt_pk_bf16_f32 v48, v48, v49
    v_cvt_pk_bf16_f32 v49, v50, v51
    v_cvt_pk_bf16_f32 v50, v52, v53
    v_cvt_pk_bf16_f32 v51, v54, v55
    s_nop 1
    v_mfma_f32_16x16x32_bf16 v[88:91], v[20:23], v[48:51], v[88:91]
    v_mfma_f32_32x32x16_bf16 v[240:255], v[232:235], v[48:51], v[240:255]
    v_exp_f32 v56, v56
    v_exp_f32 v57, v57
    v_exp_f32 v58, v58
    v_exp_f32 v59, v59
    v_exp_f32 v60, v60
    v_exp_f32 v61, v61
    v_exp_f32 v62, v62
    v_exp_f32 v63, v63
    v_cvt_pk_bf16_f32 v56, v56, v57
    v_cvt_pk_bf16_f32 v57, v58, v59
    v_cvt_pk_bf16_f32 v58, v60, v61
    v_cvt_pk_bf16_f32 v59, v62, v63
    s_nop 1
    v_mfma_f32_16x16x32_bf16 v[88:91], v[20:23], v[56:59], v[88:91]
    v_mfma_f32_32x32x16_bf16 v[240:255], v[236:239], v[56:59], v[240:255]
    s_nop 3
    v_rcp_f32 v89, v88
    s_nop 6
    v_fmac_f32 v176, v240, v89
    v_fmac_f32 v177, v241, v89
    v_fmac_f32 v178, v242, v89
    v_fmac_f32 v179, v243, v89
    v_fmac_f32 v180, v244, v89
    v_fmac_f32 v181, v245, v89
    v_fmac_f32 v182, v246, v89
    v_fmac_f32 v183, v247, v89
    v_fmac_f32 v184, v248, v89
    v_fmac_f32 v185, v249, v89
    v_fmac_f32 v186, v250, v89
    v_fmac_f32 v187, v251, v89
    v_fmac_f32 v188, v252, v89
    v_fmac_f32 v189, v253, v89
    v_fmac_f32 v190, v254, v89
    v_fmac_f32 v191, v255, v89
    v_cvt_pk_bf16_f32 v176, v176, v177
    v_cvt_pk_bf16_f32 v177, v178, v179
    v_cvt_pk_bf16_f32 v178, v180, v181
    v_cvt_pk_bf16_f32 v179, v182, v183
    v_cvt_pk_bf16_f32 v180, v184, v185
    v_cvt_pk_bf16_f32 v181, v186, v187
    v_cvt_pk_bf16_f32 v182, v188, v189
    v_cvt_pk_bf16_f32 v183, v190, v191
    v_pk_max_i16 v176, v176, 0
    v_pk_max_i16 v177, v177, 0
    v_pk_max_i16 v178, v178, 0
    v_pk_max_i16 v179, v179, 0
    v_pk_max_i16 v180, v180, 0
    v_pk_max_i16 v181, v181, 0
    v_pk_max_i16 v182, v182, 0
    v_pk_max_i16 v183, v183, 0
    ds_write_b128 v9, v[176:179]
    ds_write_b128 v10, v[180:183]
    ds_read_b128 v[184:187], v11 offset:0
    ds_read_b128 v[188:191], v11 offset:1024
    s_waitcnt lgkmcnt(1)
    buffer_store_dwordx4 v[184:187], v12, s[24:27], 0 offen offset:0 sc0 sc1 nt
    s_waitcnt lgkmcnt(0)
    buffer_store_dwordx4 v[188:191], v12, s[24:27], 0 offen offset:2048 sc0 sc1 nt
    ds_read_b128 v[128:131], v1 offset:4096
    ds_read_b128 v[132:135], v2 offset:4096
    ds_read_b128 v[136:139], v3 offset:4096
    ds_read_b128 v[140:143], v4 offset:4096
    s_waitcnt lgkmcnt(3)
    v_mfma_f32_32x32x16_bf16 v[144:159], v[64:67], v[128:131], 0
    s_waitcnt lgkmcnt(2)
    v_mfma_f32_32x32x16_bf16 v[144:159], v[68:71], v[132:135], v[144:159]
    s_waitcnt lgkmcnt(1)
    v_mfma_f32_32x32x16_bf16 v[144:159], v[72:75], v[136:139], v[144:159]
    s_waitcnt lgkmcnt(0)
    v_mfma_f32_32x32x16_bf16 v[144:159], v[76:79], v[140:143], v[144:159]
    s_nop 11
    v_cvt_pk_bf16_f32 v88, v144, v145
    v_cvt_pk_bf16_f32 v89, v146, v147
    v_cvt_pk_bf16_f32 v90, v148, v149
    v_cvt_pk_bf16_f32 v91, v150, v151
    v_cvt_pk_bf16_f32 v92, v152, v153
    v_cvt_pk_bf16_f32 v93, v154, v155
    v_cvt_pk_bf16_f32 v94, v156, v157
    v_cvt_pk_bf16_f32 v95, v158, v159
    v_mfma_f32_32x32x16_bf16 v[192:207], v[112:115], v[128:131], 0
    v_mfma_f32_32x32x16_bf16 v[192:207], v[116:119], v[132:135], v[192:207]
    v_mfma_f32_32x32x16_bf16 v[192:207], v[120:123], v[136:139], v[192:207]
    v_mfma_f32_32x32x16_bf16 v[192:207], v[124:127], v[140:143], v[192:207]
    v_mfma_f32_32x32x16_bf16 v[32:47], v[96:99], v[88:91], 0
    v_mfma_f32_32x32x16_bf16 v[32:47], v[100:103], v[92:95], v[32:47]
    v_mfma_f32_32x32x16_bf16 v[208:223], v[160:163], v[88:91], 0
    v_mfma_f32_32x32x16_bf16 v[208:223], v[164:167], v[92:95], v[208:223]
    v_mfma_f32_32x32x16_bf16 v[48:63], v[224:227], v[88:91], 0
    v_mfma_f32_32x32x16_bf16 v[48:63], v[228:231], v[92:95], v[48:63]
    v_mfma_f32_16x16x32_bf16 v[240:243], v[80:83], v[88:91], 0
    v_mfma_f32_16x16x32_bf16 v[240:243], v[84:87], v[92:95], v[240:243]
    v_max_f32 v30, v32, v33
    v_max3_f32 v30, v34, v35, v30
    v_max3_f32 v30, v36, v37, v30
    v_max3_f32 v30, v38, v39, v30
    v_max3_f32 v30, v40, v41, v30
    v_max3_f32 v30, v42, v43, v30
    v_max3_f32 v30, v44, v45, v30
    v_max3_f32 v30, v46, v47, v30
    v_max3_f32 v30, v208, v209, v30
    v_max3_f32 v30, v210, v211, v30
    v_max3_f32 v30, v212, v213, v30
    v_max3_f32 v30, v214, v215, v30
    v_max3_f32 v30, v216, v217, v30
    v_max3_f32 v30, v218, v219, v30
    v_max3_f32 v30, v220, v221, v30
    v_max3_f32 v30, v222, v223, v30
    v_max3_f32 v30, v48, v49, v30
    v_max3_f32 v30, v50, v51, v30
    v_max3_f32 v30, v52, v53, v30
    v_max3_f32 v30, v54, v55, v30
    v_max3_f32 v30, v56, v57, v30
    v_max3_f32 v30, v58, v59, v30
    v_max3_f32 v30, v60, v61, v30
    v_max3_f32 v30, v62, v63, v30
    v_max3_f32 v30, v240, v241, v30
    v_mov_b32 v31, v30
    s_nop 1
    v_permlane32_swap_b32 v30, v31
    v_max_f32 v30, v30, v31
    v_sub_f32 v32, v32, v30
    v_sub_f32 v33, v33, v30
    v_sub_f32 v34, v34, v30
    v_sub_f32 v35, v35, v30
    v_sub_f32 v36, v36, v30
    v_sub_f32 v37, v37, v30
    v_sub_f32 v38, v38, v30
    v_sub_f32 v39, v39, v30
    v_sub_f32 v40, v40, v30
    v_sub_f32 v41, v41, v30
    v_sub_f32 v42, v42, v30
    v_sub_f32 v43, v43, v30
    v_sub_f32 v44, v44, v30
    v_sub_f32 v45, v45, v30
    v_sub_f32 v46, v46, v30
    v_sub_f32 v47, v47, v30
    v_sub_f32 v208, v208, v30
    v_sub_f32 v209, v209, v30
    v_sub_f32 v210, v210, v30
    v_sub_f32 v211, v211, v30
    v_sub_f32 v212, v212, v30
    v_sub_f32 v213, v213, v30
    v_sub_f32 v214, v214, v30
    v_sub_f32 v215, v215, v30
    v_sub_f32 v216, v216, v30
    v_sub_f32 v217, v217, v30
    v_sub_f32 v218, v218, v30
    v_sub_f32 v219, v219, v30
    v_sub_f32 v220, v220, v30
    v_sub_f32 v221, v221, v30
    v_sub_f32 v222, v222, v30
    v_sub_f32 v223, v223, v30
    v_sub_f32 v48, v48, v30
    v_sub_f32 v49, v49, v30
    v_sub_f32 v50, v50, v30
    v_sub_f32 v51, v51, v30
    v_sub_f32 v52, v52, v30
    v_sub_f32 v53, v53, v30
    v_sub_f32 v54, v54, v30
    v_sub_f32 v55, v55, v30
    v_sub_f32 v56, v56, v30
    v_sub_f32 v57, v57, v30
    v_sub_f32 v58, v58, v30
    v_sub_f32 v59, v59, v30
    v_sub_f32 v60, v60, v30
    v_sub_f32 v61, v61, v30
    v_sub_f32 v62, v62, v30
    v_sub_f32 v63, v63, v30
    v_sub_f32 v240, v240, v30
    v_sub_f32 v241, v241, v30
    v_exp_f32 v240, v240
    v_exp_f32 v241, v241
    s_nop 0
    v_cvt_pk_bf16_f32 v18, v240, v241
    s_nop 1
    v_mfma_f32_32x32x8_bf16 v[176:191], v[24:25], v[18:19], 0
    v_mfma_f32_16x16x16_bf16 v[88:91], v[20:21], v[18:19], 0
    v_exp_f32 v32, v32
    v_exp_f32 v33, v33
    v_exp_f32 v34, v34
    v_exp_f32 v35, v35
    v_exp_f32 v36, v36
    v_exp_f32 v37, v37
    v_exp_f32 v38, v38
    v_exp_f32 v39, v39
    v_cvt_pk_bf16_f32 v32, v32, v33
    v_cvt_pk_bf16_f32 v33, v34, v35
    v_cvt_pk_bf16_f32 v34, v36, v37
    v_cvt_pk_bf16_f32 v35, v38, v39
    s_nop 1
    v_mfma_f32_16x16x32_bf16 v[88:91], v[20:23], v[32:35], v[88:91]
    v_mfma_f32_32x32x16_bf16 v[176:191], v[104:107], v[32:35], v[176:191]
    v_exp_f32 v40, v40
    v_exp_f32 v41, v41
    v_exp_f32 v42, v42
    v_exp_f32 v43, v43
    v_exp_f32 v44, v44
    v_exp_f32 v45, v45
    v_exp_f32 v46, v46
    v_exp_f32 v47, v47
    v_cvt_pk_bf16_f32 v40, v40, v41
    v_cvt_pk_bf16_f32 v41, v42, v43
    v_cvt_pk_bf16_f32 v42, v44, v45
    v_cvt_pk_bf16_f32 v43, v46, v47
    s_nop 1
    v_mfma_f32_16x16x32_bf16 v[88:91], v[20:23], v[40:43], v[88:91]
    v_mfma_f32_32x32x16_bf16 v[176:191], v[108:111], v[40:43], v[176:191]
    v_exp_f32 v208, v208
    v_exp_f32 v209, v209
    v_exp_f32 v210, v210
    v_exp_f32 v211, v211
    v_exp_f32 v212, v212
    v_exp_f32 v213, v213
    v_exp_f32 v214, v214
    v_exp_f32 v215, v215
    v_cvt_pk_bf16_f32 v208, v208, v209
    v_cvt_pk_bf16_f32 v209, v210, v211
    v_cvt_pk_bf16_f32 v210, v212, v213
    v_cvt_pk_bf16_f32 v211, v214, v215
    s_nop 1
    v_mfma_f32_16x16x32_bf16 v[88:91], v[20:23], v[208:211], v[88:91]
    v_mfma_f32_32x32x16_bf16 v[176:191], v[168:171], v[208:211], v[176:191]
    v_exp_f32 v216, v216
    v_exp_f32 v217, v217
    v_exp_f32 v218, v218
    v_exp_f32 v219, v219
    v_exp_f32 v220, v220
    v_exp_f32 v221, v221
    v_exp_f32 v222, v222
    v_exp_f32 v223, v223
    v_cvt_pk_bf16_f32 v216, v216, v217
    v_cvt_pk_bf16_f32 v217, v218, v219
    v_cvt_pk_bf16_f32 v218, v220, v221
    v_cvt_pk_bf16_f32 v219, v222, v223
    s_nop 1
    v_mfma_f32_16x16x32_bf16 v[88:91], v[20:23], v[216:219], v[88:91]
    v_mfma_f32_32x32x16_bf16 v[176:191], v[172:175], v[216:219], v[176:191]
    v_exp_f32 v48, v48
    v_exp_f32 v49, v49
    v_exp_f32 v50, v50
    v_exp_f32 v51, v51
    v_exp_f32 v52, v52
    v_exp_f32 v53, v53
    v_exp_f32 v54, v54
    v_exp_f32 v55, v55
    v_cvt_pk_bf16_f32 v48, v48, v49
    v_cvt_pk_bf16_f32 v49, v50, v51
    v_cvt_pk_bf16_f32 v50, v52, v53
    v_cvt_pk_bf16_f32 v51, v54, v55
    s_nop 1
    v_mfma_f32_16x16x32_bf16 v[88:91], v[20:23], v[48:51], v[88:91]
    v_mfma_f32_32x32x16_bf16 v[176:191], v[232:235], v[48:51], v[176:191]
    v_exp_f32 v56, v56
    v_exp_f32 v57, v57
    v_exp_f32 v58, v58
    v_exp_f32 v59, v59
    v_exp_f32 v60, v60
    v_exp_f32 v61, v61
    v_exp_f32 v62, v62
    v_exp_f32 v63, v63
    v_cvt_pk_bf16_f32 v56, v56, v57
    v_cvt_pk_bf16_f32 v57, v58, v59
    v_cvt_pk_bf16_f32 v58, v60, v61
    v_cvt_pk_bf16_f32 v59, v62, v63
    s_nop 1
    v_mfma_f32_16x16x32_bf16 v[88:91], v[20:23], v[56:59], v[88:91]
    v_mfma_f32_32x32x16_bf16 v[176:191], v[236:239], v[56:59], v[176:191]
    s_nop 3
    v_rcp_f32 v89, v88
    s_nop 6
    v_fmac_f32 v192, v176, v89
    v_fmac_f32 v193, v177, v89
    v_fmac_f32 v194, v178, v89
    v_fmac_f32 v195, v179, v89
    v_fmac_f32 v196, v180, v89
    v_fmac_f32 v197, v181, v89
    v_fmac_f32 v198, v182, v89
    v_fmac_f32 v199, v183, v89
    v_fmac_f32 v200, v184, v89
    v_fmac_f32 v201, v185, v89
    v_fmac_f32 v202, v186, v89
    v_fmac_f32 v203, v187, v89
    v_fmac_f32 v204, v188, v89
    v_fmac_f32 v205, v189, v89
    v_fmac_f32 v206, v190, v89
    v_fmac_f32 v207, v191, v89
    v_cvt_pk_bf16_f32 v192, v192, v193
    v_cvt_pk_bf16_f32 v193, v194, v195
    v_cvt_pk_bf16_f32 v194, v196, v197
    v_cvt_pk_bf16_f32 v195, v198, v199
    v_cvt_pk_bf16_f32 v196, v200, v201
    v_cvt_pk_bf16_f32 v197, v202, v203
    v_cvt_pk_bf16_f32 v198, v204, v205
    v_cvt_pk_bf16_f32 v199, v206, v207
    v_pk_max_i16 v192, v192, 0
    v_pk_max_i16 v193, v193, 0
    v_pk_max_i16 v194, v194, 0
    v_pk_max_i16 v195, v195, 0
    v_pk_max_i16 v196, v196, 0
    v_pk_max_i16 v197, v197, 0
    v_pk_max_i16 v198, v198, 0
    v_pk_max_i16 v199, v199, 0
    ds_write_b128 v9, v[192:195]
    ds_write_b128 v10, v[196:199]
    ds_read_b128 v[200:203], v11 offset:0
    ds_read_b128 v[204:207], v11 offset:1024
    s_waitcnt lgkmcnt(1)
    buffer_store_dwordx4 v[200:203], v12, s[24:27], s39 offen offset:0 sc0 sc1 nt
    s_waitcnt lgkmcnt(0)
    buffer_store_dwordx4 v[204:207], v12, s[24:27], s39 offen offset:2048 sc0 sc1 nt
    ds_read_b128 v[144:147], v1 offset:8192
    ds_read_b128 v[148:151], v2 offset:8192
    ds_read_b128 v[152:155], v3 offset:8192
    ds_read_b128 v[156:159], v4 offset:8192
    s_waitcnt lgkmcnt(3)
    v_mfma_f32_32x32x16_bf16 v[128:143], v[64:67], v[144:147], 0
    s_waitcnt lgkmcnt(2)
    v_mfma_f32_32x32x16_bf16 v[128:143], v[68:71], v[148:151], v[128:143]
    s_waitcnt lgkmcnt(1)
    v_mfma_f32_32x32x16_bf16 v[128:143], v[72:75], v[152:155], v[128:143]
    s_waitcnt lgkmcnt(0)
    v_mfma_f32_32x32x16_bf16 v[128:143], v[76:79], v[156:159], v[128:143]
    s_nop 11
    v_cvt_pk_bf16_f32 v88, v128, v129
    v_cvt_pk_bf16_f32 v89, v130, v131
    v_cvt_pk_bf16_f32 v90, v132, v133
    v_cvt_pk_bf16_f32 v91, v134, v135
    v_cvt_pk_bf16_f32 v92, v136, v137
    v_cvt_pk_bf16_f32 v93, v138, v139
    v_cvt_pk_bf16_f32 v94, v140, v141
    v_cvt_pk_bf16_f32 v95, v142, v143
    v_mfma_f32_32x32x16_bf16 v[240:255], v[112:115], v[144:147], 0
    v_mfma_f32_32x32x16_bf16 v[240:255], v[116:119], v[148:151], v[240:255]
    v_mfma_f32_32x32x16_bf16 v[240:255], v[120:123], v[152:155], v[240:255]
    v_mfma_f32_32x32x16_bf16 v[240:255], v[124:127], v[156:159], v[240:255]
    v_mfma_f32_32x32x16_bf16 v[32:47], v[96:99], v[88:91], 0
    v_mfma_f32_32x32x16_bf16 v[32:47], v[100:103], v[92:95], v[32:47]
    v_mfma_f32_32x32x16_bf16 v[208:223], v[160:163], v[88:91], 0
    v_mfma_f32_32x32x16_bf16 v[208:223], v[164:167], v[92:95], v[208:223]
    v_mfma_f32_32x32x16_bf16 v[48:63], v[224:227], v[88:91], 0
    v_mfma_f32_32x32x16_bf16 v[48:63], v[228:231], v[92:95], v[48:63]
    v_mfma_f32_16x16x32_bf16 v[176:179], v[80:83], v[88:91], 0
    v_mfma_f32_16x16x32_bf16 v[176:179], v[84:87], v[92:95], v[176:179]
    v_max_f32 v30, v32, v33
    v_max3_f32 v30, v34, v35, v30
    v_max3_f32 v30, v36, v37, v30
    v_max3_f32 v30, v38, v39, v30
    v_max3_f32 v30, v40, v41, v30
    v_max3_f32 v30, v42, v43, v30
    v_max3_f32 v30, v44, v45, v30
    v_max3_f32 v30, v46, v47, v30
    v_max3_f32 v30, v208, v209, v30
    v_max3_f32 v30, v210, v211, v30
    v_max3_f32 v30, v212, v213, v30
    v_max3_f32 v30, v214, v215, v30
    v_max3_f32 v30, v216, v217, v30
    v_max3_f32 v30, v218, v219, v30
    v_max3_f32 v30, v220, v221, v30
    v_max3_f32 v30, v222, v223, v30
    v_max3_f32 v30, v48, v49, v30
    v_max3_f32 v30, v50, v51, v30
    v_max3_f32 v30, v52, v53, v30
    v_max3_f32 v30, v54, v55, v30
    v_max3_f32 v30, v56, v57, v30
    v_max3_f32 v30, v58, v59, v30
    v_max3_f32 v30, v60, v61, v30
    v_max3_f32 v30, v62, v63, v30
    v_max3_f32 v30, v176, v177, v30
    v_mov_b32 v31, v30
    s_nop 1
    v_permlane32_swap_b32 v30, v31
    v_max_f32 v30, v30, v31
    v_sub_f32 v32, v32, v30
    v_sub_f32 v33, v33, v30
    v_sub_f32 v34, v34, v30
    v_sub_f32 v35, v35, v30
    v_sub_f32 v36, v36, v30
    v_sub_f32 v37, v37, v30
    v_sub_f32 v38, v38, v30
    v_sub_f32 v39, v39, v30
    v_sub_f32 v40, v40, v30
    v_sub_f32 v41, v41, v30
    v_sub_f32 v42, v42, v30
    v_sub_f32 v43, v43, v30
    v_sub_f32 v44, v44, v30
    v_sub_f32 v45, v45, v30
    v_sub_f32 v46, v46, v30
    v_sub_f32 v47, v47, v30
    v_sub_f32 v208, v208, v30
    v_sub_f32 v209, v209, v30
    v_sub_f32 v210, v210, v30
    v_sub_f32 v211, v211, v30
    v_sub_f32 v212, v212, v30
    v_sub_f32 v213, v213, v30
    v_sub_f32 v214, v214, v30
    v_sub_f32 v215, v215, v30
    v_sub_f32 v216, v216, v30
    v_sub_f32 v217, v217, v30
    v_sub_f32 v218, v218, v30
    v_sub_f32 v219, v219, v30
    v_sub_f32 v220, v220, v30
    v_sub_f32 v221, v221, v30
    v_sub_f32 v222, v222, v30
    v_sub_f32 v223, v223, v30
    v_sub_f32 v48, v48, v30
    v_sub_f32 v49, v49, v30
    v_sub_f32 v50, v50, v30
    v_sub_f32 v51, v51, v30
    v_sub_f32 v52, v52, v30
    v_sub_f32 v53, v53, v30
    v_sub_f32 v54, v54, v30
    v_sub_f32 v55, v55, v30
    v_sub_f32 v56, v56, v30
    v_sub_f32 v57, v57, v30
    v_sub_f32 v58, v58, v30
    v_sub_f32 v59, v59, v30
    v_sub_f32 v60, v60, v30
    v_sub_f32 v61, v61, v30
    v_sub_f32 v62, v62, v30
    v_sub_f32 v63, v63, v30
    v_sub_f32 v176, v176, v30
    v_sub_f32 v177, v177, v30
    v_exp_f32 v176, v176
    v_exp_f32 v177, v177
    s_nop 0
    v_cvt_pk_bf16_f32 v18, v176, v177
    s_nop 1
    v_mfma_f32_32x32x8_bf16 v[192:207], v[24:25], v[18:19], 0
    v_mfma_f32_16x16x16_bf16 v[88:91], v[20:21], v[18:19], 0
    v_exp_f32 v32, v32
    v_exp_f32 v33, v33
    v_exp_f32 v34, v34
    v_exp_f32 v35, v35
    v_exp_f32 v36, v36
    v_exp_f32 v37, v37
    v_exp_f32 v38, v38
    v_exp_f32 v39, v39
    v_cvt_pk_bf16_f32 v32, v32, v33
    v_cvt_pk_bf16_f32 v33, v34, v35
    v_cvt_pk_bf16_f32 v34, v36, v37
    v_cvt_pk_bf16_f32 v35, v38, v39
    s_nop 1
    v_mfma_f32_16x16x32_bf16 v[88:91], v[20:23], v[32:35], v[88:91]
    v_mfma_f32_32x32x16_bf16 v[192:207], v[104:107], v[32:35], v[192:207]
    v_exp_f32 v40, v40
    v_exp_f32 v41, v41
    v_exp_f32 v42, v42
    v_exp_f32 v43, v43
    v_exp_f32 v44, v44
    v_exp_f32 v45, v45
    v_exp_f32 v46, v46
    v_exp_f32 v47, v47
    v_cvt_pk_bf16_f32 v40, v40, v41
    v_cvt_pk_bf16_f32 v41, v42, v43
    v_cvt_pk_bf16_f32 v42, v44, v45
    v_cvt_pk_bf16_f32 v43, v46, v47
    s_nop 1
    v_mfma_f32_16x16x32_bf16 v[88:91], v[20:23], v[40:43], v[88:91]
    v_mfma_f32_32x32x16_bf16 v[192:207], v[108:111], v[40:43], v[192:207]
    v_exp_f32 v208, v208
    v_exp_f32 v209, v209
    v_exp_f32 v210, v210
    v_exp_f32 v211, v211
    v_exp_f32 v212, v212
    v_exp_f32 v213, v213
    v_exp_f32 v214, v214
    v_exp_f32 v215, v215
    v_cvt_pk_bf16_f32 v208, v208, v209
    v_cvt_pk_bf16_f32 v209, v210, v211
    v_cvt_pk_bf16_f32 v210, v212, v213
    v_cvt_pk_bf16_f32 v211, v214, v215
    s_nop 1
    v_mfma_f32_16x16x32_bf16 v[88:91], v[20:23], v[208:211], v[88:91]
    v_mfma_f32_32x32x16_bf16 v[192:207], v[168:171], v[208:211], v[192:207]
    v_exp_f32 v216, v216
    v_exp_f32 v217, v217
    v_exp_f32 v218, v218
    v_exp_f32 v219, v219
    v_exp_f32 v220, v220
    v_exp_f32 v221, v221
    v_exp_f32 v222, v222
    v_exp_f32 v223, v223
    v_cvt_pk_bf16_f32 v216, v216, v217
    v_cvt_pk_bf16_f32 v217, v218, v219
    v_cvt_pk_bf16_f32 v218, v220, v221
    v_cvt_pk_bf16_f32 v219, v222, v223
    s_nop 1
    v_mfma_f32_16x16x32_bf16 v[88:91], v[20:23], v[216:219], v[88:91]
    v_mfma_f32_32x32x16_bf16 v[192:207], v[172:175], v[216:219], v[192:207]
    v_exp_f32 v48, v48
    v_exp_f32 v49, v49
    v_exp_f32 v50, v50
    v_exp_f32 v51, v51
    v_exp_f32 v52, v52
    v_exp_f32 v53, v53
    v_exp_f32 v54, v54
    v_exp_f32 v55, v55
    v_cvt_pk_bf16_f32 v48, v48, v49
    v_cvt_pk_bf16_f32 v49, v50, v51
    v_cvt_pk_bf16_f32 v50, v52, v53
    v_cvt_pk_bf16_f32 v51, v54, v55
    s_nop 1
    v_mfma_f32_16x16x32_bf16 v[88:91], v[20:23], v[48:51], v[88:91]
    v_mfma_f32_32x32x16_bf16 v[192:207], v[232:235], v[48:51], v[192:207]
    v_exp_f32 v56, v56
    v_exp_f32 v57, v57
    v_exp_f32 v58, v58
    v_exp_f32 v59, v59
    v_exp_f32 v60, v60
    v_exp_f32 v61, v61
    v_exp_f32 v62, v62
    v_exp_f32 v63, v63
    v_cvt_pk_bf16_f32 v56, v56, v57
    v_cvt_pk_bf16_f32 v57, v58, v59
    v_cvt_pk_bf16_f32 v58, v60, v61
    v_cvt_pk_bf16_f32 v59, v62, v63
    s_nop 1
    v_mfma_f32_16x16x32_bf16 v[88:91], v[20:23], v[56:59], v[88:91]
    v_mfma_f32_32x32x16_bf16 v[192:207], v[236:239], v[56:59], v[192:207]
    s_nop 3
    v_rcp_f32 v89, v88
    s_nop 6
    v_fmac_f32 v240, v192, v89
    v_fmac_f32 v241, v193, v89
    v_fmac_f32 v242, v194, v89
    v_fmac_f32 v243, v195, v89
    v_fmac_f32 v244, v196, v89
    v_fmac_f32 v245, v197, v89
    v_fmac_f32 v246, v198, v89
    v_fmac_f32 v247, v199, v89
    v_fmac_f32 v248, v200, v89
    v_fmac_f32 v249, v201, v89
    v_fmac_f32 v250, v202, v89
    v_fmac_f32 v251, v203, v89
    v_fmac_f32 v252, v204, v89
    v_fmac_f32 v253, v205, v89
    v_fmac_f32 v254, v206, v89
    v_fmac_f32 v255, v207, v89
    v_cvt_pk_bf16_f32 v240, v240, v241
    v_cvt_pk_bf16_f32 v241, v242, v243
    v_cvt_pk_bf16_f32 v242, v244, v245
    v_cvt_pk_bf16_f32 v243, v246, v247
    v_cvt_pk_bf16_f32 v244, v248, v249
    v_cvt_pk_bf16_f32 v245, v250, v251
    v_cvt_pk_bf16_f32 v246, v252, v253
    v_cvt_pk_bf16_f32 v247, v254, v255
    v_pk_max_i16 v240, v240, 0
    v_pk_max_i16 v241, v241, 0
    v_pk_max_i16 v242, v242, 0
    v_pk_max_i16 v243, v243, 0
    v_pk_max_i16 v244, v244, 0
    v_pk_max_i16 v245, v245, 0
    v_pk_max_i16 v246, v246, 0
    v_pk_max_i16 v247, v247, 0
    ds_write_b128 v9, v[240:243]
    ds_write_b128 v10, v[244:247]
    ds_read_b128 v[248:251], v11 offset:0
    ds_read_b128 v[252:255], v11 offset:1024
    s_waitcnt lgkmcnt(1)
    buffer_store_dwordx4 v[248:251], v12, s[24:27], s40 offen offset:0 sc0 sc1 nt
    s_waitcnt lgkmcnt(0)
    buffer_store_dwordx4 v[252:255], v12, s[24:27], s40 offen offset:2048 sc0 sc1 nt
    ds_read_b128 v[88:91], v6 offset:0
    ds_read_b128 v[92:95], v6 offset:256
    ds_read_b64 v[30:31], v7 offset:4096
    s_waitcnt lgkmcnt(2)
    v_mfma_f32_16x16x32_bf16 v[64:67], v[88:91], v[96:99], 0
    s_waitcnt lgkmcnt(1)
    v_mfma_f32_16x16x32_bf16 v[64:67], v[92:95], v[100:103], v[64:67]
    v_mfma_f32_16x16x32_bf16 v[68:71], v[88:91], v[160:163], 0
    v_mfma_f32_16x16x32_bf16 v[68:71], v[92:95], v[164:167], v[68:71]
    v_mfma_f32_16x16x32_bf16 v[72:75], v[88:91], v[224:227], 0
    v_mfma_f32_16x16x32_bf16 v[72:75], v[92:95], v[228:231], v[72:75]
    v_mfma_f32_16x16x32_bf16 v[76:79], v[88:91], v[80:83], 0
    v_mfma_f32_16x16x32_bf16 v[76:79], v[92:95], v[84:87], v[76:79]
    v_and_b32 v96, 0x16, v0
    v_cmp_eq_u32 vcc, 0, v96
    s_nop 4
    v_cndmask_b32 v96, v64, v76, vcc
    v_max3_f32 v96, v96, v64, v68
    v_max_f32 v96, v96, v72
    s_nop 1
    v_max_f32_dpp v96, v96, v96 row_ror:1 row_mask:0xf bank_mask:0xf
    s_nop 1
    v_max_f32_dpp v96, v96, v96 row_ror:2 row_mask:0xf bank_mask:0xf
    s_nop 1
    v_max_f32_dpp v96, v96, v96 row_ror:4 row_mask:0xf bank_mask:0xf
    s_nop 1
    v_max_f32_dpp v96, v96, v96 row_ror:8 row_mask:0xf bank_mask:0xf
    v_mov_b32 v66, v96
    s_nop 1
    v_permlane16_swap_b32 v96, v66
    v_max_f32 v96, v96, v66
    v_sub_f32 v64, v64, v96
    v_sub_f32 v68, v68, v96
    v_sub_f32 v72, v72, v96
    v_sub_f32 v76, v76, v96
    v_min_f32 v76, 0, v76
    v_cndmask_b32 v97, v65, v77, vcc
    v_max3_f32 v97, v97, v65, v69
    v_max_f32 v97, v97, v73
    s_nop 1
    v_max_f32_dpp v97, v97, v97 row_ror:1 row_mask:0xf bank_mask:0xf
    s_nop 1
    v_max_f32_dpp v97, v97, v97 row_ror:2 row_mask:0xf bank_mask:0xf
    s_nop 1
    v_max_f32_dpp v97, v97, v97 row_ror:4 row_mask:0xf bank_mask:0xf
    s_nop 1
    v_max_f32_dpp v97, v97, v97 row_ror:8 row_mask:0xf bank_mask:0xf
    v_mov_b32 v66, v97
    s_nop 1
    v_permlane16_swap_b32 v97, v66
    v_max_f32 v97, v97, v66
    v_sub_f32 v65, v65, v97
    v_sub_f32 v69, v69, v97
    v_sub_f32 v73, v73, v97
    v_sub_f32 v77, v77, v97
    v_min_f32 v77, 0, v77
    v_exp_f32 v64, v64
    v_exp_f32 v65, v65
    s_nop 0
    v_cvt_pk_bf16_f32 v64, v64, v65
    ds_write_b16 v14, v64 offset:0
    ds_write_b16_d16_hi v14, v64 offset:272
    v_exp_f32 v68, v68
    v_exp_f32 v69, v69
    s_nop 0
    v_cvt_pk_bf16_f32 v68, v68, v69
    ds_write_b16 v14, v68 offset:64
    ds_write_b16_d16_hi v14, v68 offset:336
    v_exp_f32 v72, v72
    v_exp_f32 v73, v73
    s_nop 0
    v_cvt_pk_bf16_f32 v72, v72, v73
    ds_write_b16 v14, v72 offset:128
    ds_write_b16_d16_hi v14, v72 offset:400
    v_exp_f32 v76, v76
    v_exp_f32 v77, v77
    s_nop 0
    v_cvt_pk_bf16_f32 v76, v76, v77
    ds_write_b16 v15, v76 offset:0
    ds_write_b16_d16_hi v15, v76 offset:272
    ds_read_b64 v[98:99], v16 offset:192
    ds_read_b128 v[112:115], v16 offset:0
    ds_read_b128 v[116:119], v16 offset:32
    ds_read_b128 v[120:123], v16 offset:64
    ds_read_b128 v[124:127], v16 offset:96
    ds_read_b128 v[128:131], v16 offset:128
    ds_read_b128 v[132:135], v16 offset:160
    v_mov_b32 v136, 0x3f803f80
    v_mov_b32 v137, 0x3f803f80
    v_mov_b32 v138, 0x3f803f80
    v_mov_b32 v139, 0x3f803f80
    v_mov_b32 v140, 0x3f803f80
    v_mov_b32 v141, 0
    s_waitcnt lgkmcnt(6)
    v_mfma_f32_16x16x16_bf16 v[100:103], v[98:99], v[24:25], 0
    v_mfma_f32_16x16x16_bf16 v[160:163], v[98:99], v[140:141], 0
    s_waitcnt lgkmcnt(5)
    v_mfma_f32_16x16x32_bf16 v[100:103], v[112:115], v[104:107], v[100:103]
    v_mfma_f32_16x16x32_bf16 v[160:163], v[112:115], v[136:139], v[160:163]
    s_waitcnt lgkmcnt(4)
    v_mfma_f32_16x16x32_bf16 v[100:103], v[116:119], v[108:111], v[100:103]
    v_mfma_f32_16x16x32_bf16 v[160:163], v[116:119], v[136:139], v[160:163]
    s_waitcnt lgkmcnt(3)
    v_mfma_f32_16x16x32_bf16 v[100:103], v[120:123], v[168:171], v[100:103]
    v_mfma_f32_16x16x32_bf16 v[160:163], v[120:123], v[136:139], v[160:163]
    s_waitcnt lgkmcnt(2)
    v_mfma_f32_16x16x32_bf16 v[100:103], v[124:127], v[172:175], v[100:103]
    v_mfma_f32_16x16x32_bf16 v[160:163], v[124:127], v[136:139], v[160:163]
    s_waitcnt lgkmcnt(1)
    v_mfma_f32_16x16x32_bf16 v[100:103], v[128:131], v[232:235], v[100:103]
    v_mfma_f32_16x16x32_bf16 v[160:163], v[128:131], v[136:139], v[160:163]
    s_waitcnt lgkmcnt(0)
    v_mfma_f32_16x16x32_bf16 v[100:103], v[132:135], v[236:239], v[100:103]
    v_mfma_f32_16x16x32_bf16 v[160:163], v[132:135], v[136:139], v[160:163]
    s_nop 7
    v_rcp_f32 v162, v160
    s_nop 0
    v_fma_f32 v100, v100, v162, v30
    v_rcp_f32 v163, v161
    s_nop 0
    v_fma_f32 v101, v101, v163, v31
    v_cvt_pk_bf16_f32 v100, v100, v101
    v_pk_max_i16 v100, v100, 0
    buffer_store_short v100, v13, s[24:27], 0 offen sc0 sc1 nt
    buffer_store_short_d16_hi v100, v13, s[24:27], 0 offen offset:128 sc0 sc1 nt
    s_endpgm
.section .rodata,"a"
.p2align 6
.amdhsa_kernel standalone__attention_interact_autoint__recsys_kernel
  .amdhsa_next_free_vgpr 256
  .amdhsa_next_free_sgpr 102
  .amdhsa_accum_offset 256
  .amdhsa_group_segment_fixed_size 0
  .amdhsa_kernarg_size 64
  .amdhsa_user_sgpr_count 2
  .amdhsa_user_sgpr_kernarg_segment_ptr 1
  .amdhsa_system_sgpr_workgroup_id_x 1
.end_amdhsa_kernel
```
